```python
import torch

def _softmax(x, axis=-1):
    return torch.softmax(x, dim=axis)
def _gelu(x):
    return torch.nn.functional.gelu(x, approximate="tanh")
def _silu(x):
    return torch.nn.functional.silu(x)
def _sigmoid(x):
    return torch.sigmoid(x)
def _layernorm(x, axis=-1, eps=1e-5):
    m = x.mean(dim=axis, keepdim=True)
    v = x.var(dim=axis, keepdim=True, unbiased=False)
    return (x - m) / torch.sqrt(v + eps)
def _scatter_add(tgt, idx, src, axis=0):
    return tgt.clone().index_add_(axis, idx, src)
def _segment_sum(src, seg, n):
    out = torch.zeros((n,) + src.shape[1:], dtype=src.dtype)
    return out.index_add_(0, seg, src)
def _pad(x, pw):
    flat = tuple(v for pair in reversed(pw) for v in pair)
    return torch.nn.functional.pad(x, flat)

kernel_name = 'sequential_preLN__compressed_kv_cla__dense_activation_silu__decode'

def setup_inputs():

    _w = (lambda a: (lambda t: t.to(torch.bfloat16) if t.is_floating_point() else t)(torch.as_tensor(a)))
    def _A_setup():
        B, H, Sq, Sk, D, M = 4, 32, 1, 4096, 128, 640
        Dc = 4 * D
        return {
            "x": _w((lambda *s: torch.randn(*s, dtype=torch.bfloat16) * 0.05)(B, Sq, M)),
            "c_kv": _w((lambda *s: torch.randn(*s, dtype=torch.bfloat16) * 0.8)(B, Sk, Dc)),
            "w_q": _w((lambda *s: torch.randn(*s, dtype=torch.bfloat16) * 3.2)(M, H, D) * (M ** -0.5)),
            "w_uk": _w((lambda *s: torch.randn(*s, dtype=torch.bfloat16) * 3.2)(Dc, H, D) * (Dc ** -0.5)),
            "w_uv": _w((lambda *s: torch.randn(*s, dtype=torch.bfloat16) * 0.8)(Dc, H, D) * (Dc ** -0.5)),
            "w_o": _w((lambda *s: torch.randn(*s, dtype=torch.bfloat16) * 0.8)(H, D, M) * ((H * D) ** -0.5)),
        }
    _A_in = _A_setup()

    def _B_setup():
        B, S, D, F = 4, 1, 640, 1728
        return {
            "x": _w((lambda *s: torch.randn(*s, dtype=torch.bfloat16) * 0.05)(B, S, D)),
            "w1": _w((lambda *s: torch.randn(*s, dtype=torch.bfloat16) * 3.2)(D, F) * (D ** -0.5)),
            "w2": _w((lambda *s: torch.randn(*s, dtype=torch.bfloat16) * 0.8)(F, D) * (F ** -0.5)),
        }
    _B_in = _B_setup()

    return {
        "A_x": _A_in["x"],
        "A_c_kv": _A_in["c_kv"],
        "A_w_q": _A_in["w_q"],
        "A_w_uk": _A_in["w_uk"],
        "A_w_uv": _A_in["w_uv"],
        "A_w_o": _A_in["w_o"],
        "B_x": _B_in["x"],
        "B_w1": _B_in["w1"],
        "B_w2": _B_in["w2"],
    }

def reference(A_x, A_c_kv, A_w_q, A_w_uk, A_w_uv, A_w_o, B_x, B_w1, B_w2):
    def _A_ref(x, c_kv, w_q, w_uk, w_uv, w_o):
        B, Sq, M = x.shape[0], x.shape[1], x.shape[2]
        Sk = c_kv.shape[1]
        H, D = w_q.shape[1], w_q.shape[2]
        q = torch.einsum("bqm,mhd->bhqd", x, w_q)
        k = torch.einsum("bkc,chd->bhkd", c_kv, w_uk)
        v = torch.einsum("bkc,chd->bhkd", c_kv, w_uv)
        scores = torch.einsum("bhqd,bhkd->bhqk", q, k) * (D ** -0.5)
        off = Sk - Sq
        qi = torch.arange(Sq)[:, None]
        kj = torch.arange(Sk)[None, :]
        cmask = kj <= (qi + off)
        scores = torch.where(cmask[None, None], scores, -1e9)
        p = _softmax(scores, axis=-1)
        ctx = torch.einsum("bhqk,bhkd->bhqd", p, v)
        return torch.einsum("bhqd,hdm->bqm", ctx, w_o)

    def _B_ref(x, w1, w2):
        h = torch.einsum("bsd,df->bsf", x, w1)
        h = _silu(h)
        out = torch.einsum("bsf,fd->bsd", h, w2)
        return out

    x = A_x
    h = x + _A_ref(_layernorm(x, axis=-1), A_c_kv, A_w_q, A_w_uk, A_w_uv, A_w_o)
    h2 = h + _B_ref(_layernorm(h, axis=-1), B_w1, B_w2)
    return h2
```

```asm
; @launch grid=(256,1,1) block=(512,1,1) lds=163840
.amdgcn_target "amdgcn-amd-amdhsa--gfx950"
.text
.globl sequential_preLN__compressed_kv_cla__dense_activation_silu__decode_kernel
.p2align 8
.type sequential_preLN__compressed_kv_cla__dense_activation_silu__decode_kernel,@function
sequential_preLN__compressed_kv_cla__dense_activation_silu__decode_kernel:
    s_cmp_ge_u32 s2, 256
    s_cbranch_scc1 L_end
    s_load_dwordx16 s[16:31], s[0:1], 0
    s_load_dwordx8 s[32:39], s[0:1], 64
    s_getpc_b64 s[48:49]
L_pc:
    s_and_b32 s49, s49, 0xffff
    s_mov_b32 s50, L_code_end-L_pc
    s_mov_b32 s51, 0x20000
    v_lshlrev_b32 v1, 4, v0
    s_and_b32 s13, s2, 24
    s_lshl_b32 s13, s13, 10
    buffer_load_dwordx4 v[252:255], v1, s[48:51], s13 offen
    v_lshrrev_b32 v2, 6, v0
    v_and_b32 v1, 63, v0
    s_and_b32 s4, s2, 7
    v_readfirstlane_b32 s3, v2
    s_lshr_b32 s5, s2, 3
    s_lshr_b32 s6, s5, 3
    s_lshl2_add_u32 s6, s4, s6
    s_and_b32 s7, s5, 7
    v_lshrrev_b32 v3, 4, v1
    v_and_b32 v9, 7, v1
    v_xor_b32 v9, v9, v3
    v_and_b32 v2, 1, v2
    v_lshlrev_b32 v2, 2, v2
    v_xor_b32 v9, v2, v9
    v_lshlrev_b32 v9, 4, v9
    v_lshrrev_b32 v10, 3, v1
    v_lshl_add_u32 v9, v10, 13, v9
    s_and_b32 s12, s3, 3
    v_and_b32 v2, 15, v1
    s_and_b32 s9, s5, 1
    s_cmp_ge_u32 s3, 4
    s_cbranch_scc1 L_pwave
    s_lshr_b32 s14, s7, 1
    s_mul_i32 s64, s14, 160
    s_lshl3_add_u32 s64, s12, s64
    s_lshl_b32 s64, s64, 13
    s_lshl_b32 s13, s6, 8
    s_add_u32 s64, s64, s13
    s_lshl_b32 s71, s9, 7
    s_add_u32 s64, s64, s71
    s_lshl_b32 s68, s14, 7
    s_lshl3_add_u32 s68, s12, s68
    s_lshl_b32 s68, s68, 13
    s_add_u32 s68, s68, s13
    s_lshl_b32 s67, s12, 10
    v_mov_b32 v6, 0
    v_lshlrev_b32 v13, 2, v1
    v_add_u32 v10, 160768, v13
    v_mov_b32 v11, -1
    ds_write_b32 v10, v11 offset:0
    s_mov_b32 exec_hi, 0
    ds_write_b32 v10, v6 offset:1280
    s_mov_b64 exec, -1
    s_mov_b32 s50, 5242880
    s_mov_b32 s70, s9
    s_mov_b32 s71, 0
    s_mov_b64 vcc, s[70:71]
    s_waitcnt lgkmcnt(0)
    s_mov_b32 s48, s20
    s_and_b32 s49, s21, 0xffff
    s_barrier
    s_add_u32 m0, s67, 131072
    s_add_u32 s13, s64, 0
    buffer_load_dwordx4 v9, s[48:51], s13 offen nt lds
    s_add_u32 m0, s67, 135168
    s_add_u32 s13, s64, 262144
    buffer_load_dwordx4 v9, s[48:51], s13 offen nt lds
    s_add_u32 m0, s67, 139264
    s_add_u32 s13, s64, 524288
    buffer_load_dwordx4 v9, s[48:51], s13 offen nt lds
    s_add_u32 m0, s67, 143360
    s_add_u32 s13, s64, 786432
    buffer_load_dwordx4 v9, s[48:51], s13 offen nt lds
    s_add_u32 m0, s67, 147456
    s_add_u32 s13, s64, 1048576
    buffer_load_dwordx4 v9, s[48:51], s13 offen nt lds
    s_lshr_b32 s8, s4, 1
    s_and_b32 s10, s4, 1
    s_lshl_b32 s10, s10, 4
    s_lshr_b32 s13, s5, 1
    s_add_u32 s10, s10, s13
    v_mov_b32 v4, 162048
    v_mov_b32 v5, 1
    v_lshlrev_b32 v14, 4, v2
    v_lshl_add_u32 v14, v3, 2, v14
    v_lshlrev_b32 v15, 2, v14
    s_mov_b32 s48, s22
    s_and_b32 s49, s23, 0xffff
    s_mov_b32 s50, 4194304
    s_mov_b32 s51, 0x20000
    s_lshl_b32 s69, s12, 15
    s_cbranch_vccnz L_s_setup
    s_add_u32 m0, s69, 24576
    s_add_u32 s13, s68, 0
    buffer_load_dwordx4 v9, s[48:51], s13 offen nt lds
    s_add_u32 m0, s69, 25600
    s_add_u32 s13, s68, 128
    buffer_load_dwordx4 v9, s[48:51], s13 offen nt lds
    s_add_u32 m0, s69, 26624
    s_add_u32 s13, s68, 262144
    buffer_load_dwordx4 v9, s[48:51], s13 offen nt lds
L_s_setup:
    s_load_dword s11, s[38:39], 0
    s_mov_b32 s44, s18
    s_and_b32 s45, s19, 0xffff
    s_mov_b32 s46, 16777216
    s_mov_b32 s47, 0x20000
    s_mov_b32 s40, s38
    s_and_b32 s41, s39, 0xffff
    s_mov_b32 s42, 17825792
    s_mov_b32 s43, 0x20000
    s_add_u32 s56, s38, 1507328
    s_addc_u32 s57, s39, 0
    s_and_b32 s57, s57, 0xffff
    s_mov_b32 s58, 196608
    s_mov_b32 s59, 0x20000
    s_lshl_b32 s65, s12, 15
    v_lshrrev_b32 v10, 3, v1
    v_lshrrev_b32 v11, 1, v10
    v_and_b32 v11, 1, v11
    v_and_b32 v12, 4, v10
    v_or_b32 v11, v11, v12
    v_and_b32 v12, 7, v1
    v_xor_b32 v11, v11, v12
    v_lshlrev_b32 v11, 4, v11
    v_lshl_add_u32 v7, v10, 10, v11
    v_xor_b32 v8, 32, v7
    v_add_u32 v8, 8192, v8
    s_lshl_b32 s64, s8, 22
    s_lshl_b32 s13, s10, 17
    s_add_u32 s64, s64, s13
    s_add_u32 s64, s64, s65
    v_lshrrev_b32 v11, 1, v2
    v_and_b32 v11, 1, v11
    v_lshrrev_b32 v12, 3, v2
    v_lshl_or_b32 v11, v12, 1, v11
    v_and_b32 v10, 4, v2
    v_or_b32 v11, v11, v10
    v_xor_b32 v11, v11, v3
    v_lshlrev_b32 v11, 4, v11
    v_and_b32 v10, 7, v2
    v_lshl_add_u32 v11, v10, 7, v11
    v_lshl_add_u32 v11, v12, 10, v11
    v_add_u32 v11, s65, v11
    s_cmp_eq_u32 s9, 0
    s_cselect_b32 s74, 0, 0
    s_lshl_b32 s13, s74, 4
    s_sub_u32 s66, s64, s74
    s_add_u32 s64, s64, s74
    s_sub_u32 s67, s65, s13
    s_add_u32 s65, s65, s13
    s_sub_u32 s14, 8192, s13
    v_add_u32 v34, s14, v11
    v_add_u32 v11, s13, v11
    v_xor_b32 v12, 64, v11
    v_xor_b32 v35, 64, v34
    v_mov_b32 v17, 0
    s_cbranch_vccnz L_s_ckv
    s_waitcnt vmcnt(7)
    s_add_u32 m0, s69, 27648
    s_add_u32 s13, s68, 262272
    buffer_load_dwordx4 v9, s[48:51], s13 offen nt lds
    s_waitcnt vmcnt(7)
    s_add_u32 m0, s69, 28672
    s_add_u32 s13, s68, 524288
    buffer_load_dwordx4 v9, s[48:51], s13 offen nt lds
    s_waitcnt vmcnt(7)
    s_add_u32 m0, s69, 29696
    s_add_u32 s13, s68, 524416
    buffer_load_dwordx4 v9, s[48:51], s13 offen nt lds
    s_waitcnt vmcnt(7)
    s_add_u32 m0, s69, 30720
    s_add_u32 s13, s68, 786432
    buffer_load_dwordx4 v9, s[48:51], s13 offen nt lds
    s_waitcnt vmcnt(7)
    s_mov_b64 exec, 1
    ds_add_u32 v4, v5 offset:0
    s_mov_b64 exec, -1
    s_add_u32 m0, s69, 31744
    s_add_u32 s13, s68, 786560
    buffer_load_dwordx4 v9, s[48:51], s13 offen nt lds
    v_lshlrev_b32 v16, 4, v2
    v_add_u32 v16, 162240, v16
    v_lshrrev_b32 v17, 2, v2
    v_lshlrev_b32 v17, 13, v17
    v_and_b32 v18, 3, v2
    v_lshl_add_u32 v17, v18, 4, v17
    s_lshr_b32 s13, s7, 1
    s_lshl2_add_u32 s69, s6, s13
    s_lshl_b32 s69, s69, 6
    s_add_u32 s69, s69, 196608
    s_waitcnt vmcnt(1)
    s_mov_b64 exec, 1
    ds_add_u32 v4, v5 offset:36
    s_mov_b64 exec, -1
    s_waitcnt vmcnt(0)
    s_mov_b64 exec, 1
    ds_add_u32 v4, v5 offset:32
    s_mov_b64 exec, -1
    s_branch L_s_ckv
L_pwave:
    v_lshlrev_b32 v7, 4, v1
    v_lshlrev_b32 v8, 2, v1
    s_mul_i32 s64, s12, 1280
    s_mov_b32 s46, 5120
    s_mov_b32 s47, 0x20000
    s_setprio 3
    s_waitcnt lgkmcnt(0)
    s_mov_b32 s44, s16
    s_and_b32 s45, s17, 0xffff
    buffer_load_dwordx4 v[16:19], v7, s[44:47], s64 offen
    buffer_load_dword v20, v8, s[44:47], s64 offen offset:1024
    s_barrier
    s_load_dword s11, s[38:39], 0
    s_mov_b32 s40, s38
    s_and_b32 s41, s39, 0xffff
    s_mov_b32 s42, 17825792
    s_mov_b32 s43, 0x20000
    s_add_u32 s56, s38, 1507328
    s_addc_u32 s57, s39, 0
    s_and_b32 s57, s57, 0xffff
    s_mov_b32 s58, 196608
    s_mov_b32 s59, 0x20000
    s_lshr_b32 s8, s4, 1
    s_and_b32 s10, s4, 1
    s_lshl_b32 s10, s10, 4
    s_lshr_b32 s13, s5, 1
    s_add_u32 s10, s10, s13
    v_mov_b32 v4, 162048
    v_mov_b32 v5, 1
    v_lshlrev_b32 v14, 4, v2
    v_lshl_add_u32 v14, v3, 2, v14
    v_lshlrev_b32 v15, 2, v14
    s_lshl_b32 s68, s6, 10
    s_lshr_b32 s69, s7, 1
    s_and_b32 s14, s12, 1
    s_lshl1_add_u32 s14, s9, s14
    s_lshl2_add_u32 s14, s14, s69
    s_lshl_b32 s14, s14, 6
    s_add_u32 s66, s68, s14
    s_lshl_b32 s65, s66, 2
    s_lshl_b32 s67, s68, 2
    s_add_u32 s65, s65, 65536
    s_add_u32 s66, s66, 32768
    s_add_u32 s67, s67, 65536
    s_add_u32 s68, s68, 32768
    s_cmp_lt_u32 s12, 2
    s_cbranch_scc1 L_p_x0
    s_mov_b32 exec_lo, 0x000f000f
    s_mov_b32 exec_hi, 0x000f000f
    buffer_load_dword v250, v15, s[40:43], s65 offen sc1
    buffer_load_dword v251, v14, s[40:43], s66 offen sc1
    s_mov_b64 exec, -1
    s_waitcnt vmcnt(2)
    s_branch L_p_x1
L_p_x0:
    s_waitcnt vmcnt(0)
L_p_x1:
    v_lshlrev_b32 v24, 16, v16
    v_and_b32 v25, 0xffff0000, v16
    v_lshlrev_b32 v26, 16, v17
    v_and_b32 v27, 0xffff0000, v17
    v_lshlrev_b32 v28, 16, v18
    v_and_b32 v29, 0xffff0000, v18
    v_lshlrev_b32 v30, 16, v19
    v_and_b32 v31, 0xffff0000, v19
    v_lshlrev_b32 v32, 16, v20
    v_and_b32 v33, 0xffff0000, v20
    v_add_f32 v34, v24, v25
    v_add_f32 v35, v26, v27
    v_add_f32 v36, v28, v29
    v_add_f32 v37, v30, v31
    v_add_f32 v38, v32, v33
    v_add_f32 v34, v34, v35
    v_add_f32 v36, v36, v37
    v_add_f32 v34, v34, v38
    v_add_f32 v34, v34, v36
    s_nop 1
    v_add_f32_dpp v34, v34, v34 row_ror:8 row_mask:0xf bank_mask:0xf
    s_nop 1
    v_add_f32_dpp v34, v34, v34 row_ror:4 row_mask:0xf bank_mask:0xf
    s_nop 1
    v_add_f32_dpp v34, v34, v34 row_ror:2 row_mask:0xf bank_mask:0xf
    s_nop 1
    v_add_f32_dpp v34, v34, v34 row_ror:1 row_mask:0xf bank_mask:0xf
    v_mov_b32 v35, v34
    s_nop 1
    v_permlane16_swap_b32 v34, v35
    s_nop 0
    v_add_f32 v34, v34, v35
    v_mov_b32 v35, v34
    s_nop 1
    v_permlane32_swap_b32 v34, v35
    s_nop 0
    v_add_f32 v34, v34, v35
    v_mul_f32 v34, 0x3acccccd, v34
    v_sub_f32 v36, v24, v34
    v_mul_f32 v35, v36, v36
    v_sub_f32 v36, v25, v34
    v_fmac_f32 v35, v36, v36
    v_sub_f32 v36, v26, v34
    v_fmac_f32 v35, v36, v36
    v_sub_f32 v36, v27, v34
    v_fmac_f32 v35, v36, v36
    v_sub_f32 v36, v28, v34
    v_fmac_f32 v35, v36, v36
    v_sub_f32 v36, v29, v34
    v_fmac_f32 v35, v36, v36
    v_sub_f32 v36, v30, v34
    v_fmac_f32 v35, v36, v36
    v_sub_f32 v36, v31, v34
    v_fmac_f32 v35, v36, v36
    v_sub_f32 v36, v32, v34
    v_fmac_f32 v35, v36, v36
    v_sub_f32 v36, v33, v34
    v_fmac_f32 v35, v36, v36
    s_nop 1
    v_add_f32_dpp v35, v35, v35 row_ror:8 row_mask:0xf bank_mask:0xf
    s_nop 1
    v_add_f32_dpp v35, v35, v35 row_ror:4 row_mask:0xf bank_mask:0xf
    s_nop 1
    v_add_f32_dpp v35, v35, v35 row_ror:2 row_mask:0xf bank_mask:0xf
    s_nop 1
    v_add_f32_dpp v35, v35, v35 row_ror:1 row_mask:0xf bank_mask:0xf
    v_mov_b32 v36, v35
    s_nop 1
    v_permlane16_swap_b32 v35, v36
    s_nop 0
    v_add_f32 v35, v35, v36
    v_mov_b32 v36, v35
    s_nop 1
    v_permlane32_swap_b32 v35, v36
    s_nop 0
    v_add_f32 v35, v35, v36
    v_mul_f32 v35, 0x3acccccd, v35
    v_cvt_pk_bf16_f32 v35, v35, v35
    v_lshlrev_b32 v35, 16, v35
    v_add_f32 v35, 0x3727c5ac, v35
    v_cvt_pk_bf16_f32 v35, v35, v35
    v_lshlrev_b32 v35, 16, v35
    v_sqrt_f32 v35, v35
    v_cvt_pk_bf16_f32 v34, v34, v34
    v_lshlrev_b32 v34, 16, v34
    v_cvt_pk_bf16_f32 v35, v35, v35
    v_lshlrev_b32 v35, 16, v35
    v_rcp_f32 v35, v35
    v_sub_f32 v24, v24, v34
    v_sub_f32 v25, v25, v34
    v_sub_f32 v26, v26, v34
    v_sub_f32 v27, v27, v34
    v_sub_f32 v28, v28, v34
    v_sub_f32 v29, v29, v34
    v_sub_f32 v30, v30, v34
    v_sub_f32 v31, v31, v34
    v_sub_f32 v32, v32, v34
    v_sub_f32 v33, v33, v34
    v_cvt_pk_bf16_f32 v16, v24, v25
    v_cvt_pk_bf16_f32 v17, v26, v27
    v_cvt_pk_bf16_f32 v18, v28, v29
    v_cvt_pk_bf16_f32 v19, v30, v31
    v_cvt_pk_bf16_f32 v20, v32, v33
    v_lshlrev_b32 v24, 16, v16
    v_and_b32 v25, 0xffff0000, v16
    v_lshlrev_b32 v26, 16, v17
    v_and_b32 v27, 0xffff0000, v17
    v_lshlrev_b32 v28, 16, v18
    v_and_b32 v29, 0xffff0000, v18
    v_lshlrev_b32 v30, 16, v19
    v_and_b32 v31, 0xffff0000, v19
    v_lshlrev_b32 v32, 16, v20
    v_and_b32 v33, 0xffff0000, v20
    v_mul_f32 v24, v24, v35
    v_mul_f32 v25, v25, v35
    v_mul_f32 v26, v26, v35
    v_mul_f32 v27, v27, v35
    v_mul_f32 v28, v28, v35
    v_mul_f32 v29, v29, v35
    v_mul_f32 v30, v30, v35
    v_mul_f32 v31, v31, v35
    v_mul_f32 v32, v32, v35
    v_mul_f32 v33, v33, v35
    v_cvt_pk_bf16_f32 v16, v24, v25
    v_cvt_pk_bf16_f32 v17, v26, v27
    v_cvt_pk_bf16_f32 v18, v28, v29
    v_cvt_pk_bf16_f32 v19, v30, v31
    v_cvt_pk_bf16_f32 v20, v32, v33
    s_add_u32 s13, s64, 151552
    v_add_u32 v7, s13, v7
    v_add_u32 v8, s13, v8
    ds_write_b128 v7, v[16:19]
    ds_write_b32 v8, v20 offset:1024
    s_mov_b64 exec, 1
    ds_add_u32 v4, v5 offset:0
    s_mov_b64 exec, -1
    v_lshrrev_b32 v10, 2, v1
    v_and_b32 v10, 3, v10
    v_and_b32 v12, 1, v3
    v_lshlrev_b32 v12, 2, v12
    v_and_b32 v11, 3, v1
    v_xor_b32 v11, v11, v12
    v_lshrrev_b32 v12, 1, v10
    v_xor_b32 v11, v11, v12
    v_lshlrev_b32 v11, 4, v11
    v_lshl_add_u32 v11, v10, 7, v11
    v_lshl_add_u32 v11, v3, 10, v11
    s_and_b32 s13, s12, 1
    s_lshl_b32 s13, s13, 6
    v_xor_b32 v11, s13, v11
    v_add_u32 v11, 131072, v11
    v_xor_b32 v12, 0x220, v11
    v_and_b32 v13, 3, v2
    v_mul_u32_u24 v13, 1280, v13
    v_lshl_add_u32 v13, v3, 4, v13
    s_mul_i32 s13, s69, 320
    s_add_u32 s13, s13, 151552
    v_add_u32 v13, s13, v13
    v_lshlrev_b32 v24, 15, v2
    v_lshl_add_u32 v24, v3, 4, v24
    v_lshlrev_b32 v34, 6, v2
    v_lshl_add_u32 v34, v3, 2, v34
    s_lshl_b32 s13, s12, 4
    s_add_u32 s13, s13, 162240
    v_add_u32 v34, s13, v34
    v_and_b32 v7, 4, v2
    s_lshl2_add_u32 s13, s69, s12
    s_lshl_b32 s13, s13, 6
    s_lshl_b32 s70, s6, 10
    s_add_u32 s70, s70, s13
    s_add_u32 s70, s70, 262144
    v_lshrrev_b32 v26, 2, v2
    v_and_b32 v27, 3, v2
    v_lshrrev_b32 v25, 1, v27
    v_xor_b32 v25, v25, v3
    v_xor_b32 v25, v25, v7
    v_lshlrev_b32 v25, 4, v25
    v_lshl_add_u32 v25, v27, 7, v25
    v_lshl_add_u32 v25, v26, 15, v25
    s_lshl_b32 s13, s12, 11
    s_add_u32 s13, s13, 24576
    v_add_u32 v25, s13, v25
    v_xor_b32 v26, 64, v25
    v_xor_b32 v27, 0x220, v25
    v_xor_b32 v28, 0x260, v25
    s_mov_b32 s52, s40
    s_mov_b32 s53, s41
    s_mov_b32 s54, 196608
    s_mov_b32 s55, 0x20000
    s_mov_b32 s61, 0
    s_waitcnt lgkmcnt(0)
    s_mul_i32 s11, s11, 1664525
    s_add_u32 s11, s11, 1013904223
    s_cmp_lt_u32 s12, 2
    s_cbranch_scc1 L_p_s1
    s_cmp_lg_u32 s12, 3
    s_cbranch_scc1 L_p_nos1
    s_getreg_b32 s13, hwreg(HW_REG_XCC_ID, 0, 4)
    s_add_u32 s13, s13, s11
    v_mov_b32 v16, s13
    v_mov_b32 v17, s13
    v_mov_b32 v18, s13
    v_mov_b32 v19, s13
    v_lshlrev_b32 v22, 4, v1
    s_lshl_b32 s13, s4, 5
    s_add_u32 s13, s13, s5
    s_lshl_b32 s13, s13, 7
    s_add_u32 s13, s13, 229376
    s_mov_b64 exec, 0xff
    buffer_store_dwordx4 v[16:19], v22, s[40:43], s13 offen sc1
    s_mov_b64 exec, -1
    s_branch L_p_nos1
L_p_s1:
    s_mov_b32 s15, 0
FW_1:
    ds_read_b32 v6, v4 offset:0
    s_add_u32 s15, s15, 1
    s_cmp_gt_u32 s15, 1600000
    s_cbranch_scc1 FX_2
    s_waitcnt lgkmcnt(0)
    v_readfirstlane_b32 s14, v6
    s_cmp_lt_u32 s14, 8
    s_cbranch_scc1 FW_1
FX_2:
    ds_read_b128 v[36:39], v13 offset:0
    ds_read_b64_tr_b16 v[96:97], v11 offset:0
    ds_read_b64_tr_b16 v[98:99], v12 offset:0
    ds_read_b64_tr_b16 v[100:101], v11 offset:8
    ds_read_b64_tr_b16 v[102:103], v12 offset:8
    ds_read_b128 v[40:43], v13 offset:64
    ds_read_b64_tr_b16 v[104:105], v11 offset:4096
    ds_read_b64_tr_b16 v[106:107], v12 offset:4096
    ds_read_b64_tr_b16 v[108:109], v11 offset:4104
    ds_read_b64_tr_b16 v[110:111], v12 offset:4104
    ds_read_b128 v[44:47], v13 offset:128
    ds_read_b64_tr_b16 v[112:113], v11 offset:8192
    ds_read_b64_tr_b16 v[114:115], v12 offset:8192
    ds_read_b64_tr_b16 v[116:117], v11 offset:8200
    ds_read_b64_tr_b16 v[118:119], v12 offset:8200
    s_waitcnt lgkmcnt(10)
    v_mfma_f32_16x16x32_bf16 v[56:59], v[96:99], v[36:39], 0
    v_mfma_f32_16x16x32_bf16 v[60:63], v[100:103], v[36:39], 0
    ds_read_b128 v[48:51], v13 offset:192
    ds_read_b64_tr_b16 v[120:121], v11 offset:12288
    ds_read_b64_tr_b16 v[122:123], v12 offset:12288
    ds_read_b64_tr_b16 v[124:125], v11 offset:12296
    ds_read_b64_tr_b16 v[126:127], v12 offset:12296
    s_waitcnt lgkmcnt(10)
    v_mfma_f32_16x16x32_bf16 v[56:59], v[104:107], v[40:43], v[56:59]
    v_mfma_f32_16x16x32_bf16 v[60:63], v[108:111], v[40:43], v[60:63]
    ds_read_b128 v[52:55], v13 offset:256
    ds_read_b64_tr_b16 v[128:129], v11 offset:16384
    ds_read_b64_tr_b16 v[130:131], v12 offset:16384
    ds_read_b64_tr_b16 v[132:133], v11 offset:16392
    ds_read_b64_tr_b16 v[134:135], v12 offset:16392
    s_waitcnt lgkmcnt(10)
    v_mfma_f32_16x16x32_bf16 v[56:59], v[112:115], v[44:47], v[56:59]
    v_mfma_f32_16x16x32_bf16 v[60:63], v[116:119], v[44:47], v[60:63]
    s_waitcnt lgkmcnt(5)
    v_mfma_f32_16x16x32_bf16 v[56:59], v[120:123], v[48:51], v[56:59]
    v_mfma_f32_16x16x32_bf16 v[60:63], v[124:127], v[48:51], v[60:63]
    s_waitcnt lgkmcnt(0)
    v_mfma_f32_16x16x32_bf16 v[56:59], v[128:131], v[52:55], v[56:59]
    v_mfma_f32_16x16x32_bf16 v[60:63], v[132:135], v[52:55], v[60:63]
    s_nop 5
    s_mov_b32 exec_lo, 0x000f000f
    s_mov_b32 exec_hi, 0x000f000f
    v_cvt_pk_bf16_f32 v16, v56, v57
    v_cvt_pk_bf16_f32 v17, v58, v59
    v_cvt_pk_bf16_f32 v18, v60, v61
    v_cvt_pk_bf16_f32 v19, v62, v63
    v_add3_u32 v20, v16, v17, s11
    v_add3_u32 v20, v18, v19, v20
    buffer_store_dwordx4 v[16:19], v15, s[40:43], s65 offen
    buffer_store_dword v20, v14, s[40:43], s66 offen
    s_mov_b64 exec, 1
    ds_add_u32 v4, v5 offset:28
    s_mov_b64 exec, -1
L_p_nos1:
    s_cmp_lg_u32 s9, 0
    s_cbranch_scc1 L_p_qd
    s_mov_b32 s15, 0
FW_3:
    ds_read_b32 v6, v4 offset:32
    s_add_u32 s15, s15, 1
    s_cmp_gt_u32 s15, 1600000
    s_cbranch_scc1 FX_4
    s_waitcnt lgkmcnt(0)
    v_readfirstlane_b32 s14, v6
    s_cmp_lt_u32 s14, 4
    s_cbranch_scc1 FW_3
FX_4:
    ds_read_b128 v[64:67], v25 offset:0
    ds_read_b128 v[68:71], v26 offset:0
    ds_read_b128 v[72:75], v25 offset:1024
    ds_read_b128 v[76:79], v26 offset:1024
    ds_read_b128 v[80:83], v27 offset:0
    ds_read_b128 v[84:87], v28 offset:0
    ds_read_b128 v[88:91], v27 offset:1024
    ds_read_b128 v[92:95], v28 offset:1024
    s_mov_b64 s[62:63], -1
PL_5:
    s_cmp_lg_u32 s61, 3
    s_cbranch_scc1 ND_6
    s_cmp_ge_u32 s12, 2
    s_cbranch_scc1 QD_8
    s_mov_b32 exec_lo, 0x000f000f
    s_mov_b32 exec_hi, 0x000f000f
    buffer_store_dwordx4 v[16:19], v15, s[56:59], s65 offen sc1
    buffer_store_dword v20, v14, s[56:59], s66 offen sc1
    s_mov_b64 exec, -1
QD_8:
ND_6:
    s_mov_b64 exec, s[62:63]
    buffer_load_dwordx4 v[36:39], v15, s[52:55], s67 offen offset:0 sc1
    buffer_load_dwordx4 v[40:43], v15, s[52:55], s67 offen offset:1024 sc1
    buffer_load_dwordx4 v[44:47], v15, s[52:55], s67 offen offset:2048 sc1
    buffer_load_dwordx4 v[48:51], v15, s[52:55], s67 offen offset:3072 sc1
    buffer_load_dword v52, v14, s[52:55], s68 offen offset:0 sc1
    buffer_load_dword v53, v14, s[52:55], s68 offen offset:256 sc1
    buffer_load_dword v54, v14, s[52:55], s68 offen offset:512 sc1
    buffer_load_dword v55, v14, s[52:55], s68 offen offset:768 sc1
    s_mov_b64 exec, -1
SK_7:
    s_waitcnt vmcnt(4) lgkmcnt(0)
    v_mfma_f32_16x16x32_bf16 v[56:59], v[64:67], v[36:39], 0
    v_mfma_f32_16x16x32_bf16 v[60:63], v[80:83], v[36:39], 0
    v_mfma_f32_16x16x32_bf16 v[56:59], v[68:71], v[40:43], v[56:59]
    v_mfma_f32_16x16x32_bf16 v[60:63], v[84:87], v[40:43], v[60:63]
    v_mfma_f32_16x16x32_bf16 v[56:59], v[72:75], v[44:47], v[56:59]
    v_mfma_f32_16x16x32_bf16 v[60:63], v[88:91], v[44:47], v[60:63]
    v_mfma_f32_16x16x32_bf16 v[56:59], v[76:79], v[48:51], v[56:59]
    v_mfma_f32_16x16x32_bf16 v[60:63], v[92:95], v[48:51], v[60:63]
    s_waitcnt vmcnt(0)
    v_add3_u32 v7, v36, v37, s11
    v_add3_u32 v7, v38, v39, v7
    v_cmp_ne_u32 s[62:63], v7, v52
    v_add3_u32 v7, v40, v41, s11
    v_add3_u32 v7, v42, v43, v7
    v_cmp_ne_u32 vcc, v7, v53
    s_or_b64 s[62:63], s[62:63], vcc
    v_add3_u32 v7, v44, v45, s11
    v_add3_u32 v7, v46, v47, v7
    v_cmp_ne_u32 vcc, v7, v54
    s_or_b64 s[62:63], s[62:63], vcc
    v_add3_u32 v7, v48, v49, s11
    v_add3_u32 v7, v50, v51, v7
    v_cmp_ne_u32 vcc, v7, v55
    s_or_b64 s[62:63], s[62:63], vcc
    s_cmp_eq_u64 s[62:63], 0
    s_cbranch_scc1 PX_9
    s_add_u32 s61, s61, 1
    s_and_b32 s14, s61, 7
    s_cmp_eq_u32 s14, 7
    s_cselect_b32 s52, s56, s40
    s_cselect_b32 s53, s57, s41
    s_cmp_lt_u32 s61, 200000
    s_cbranch_scc1 PL_5
PX_9:
    v_add_f32_dpp v56, v56, v56 row_ror:4 row_mask:0xf bank_mask:0xf
    v_add_f32_dpp v57, v57, v57 row_ror:4 row_mask:0xf bank_mask:0xf
    v_add_f32_dpp v58, v58, v58 row_ror:4 row_mask:0xf bank_mask:0xf
    v_add_f32_dpp v59, v59, v59 row_ror:4 row_mask:0xf bank_mask:0xf
    v_add_f32_dpp v60, v60, v60 row_ror:4 row_mask:0xf bank_mask:0xf
    v_add_f32_dpp v61, v61, v61 row_ror:4 row_mask:0xf bank_mask:0xf
    v_add_f32_dpp v62, v62, v62 row_ror:4 row_mask:0xf bank_mask:0xf
    v_add_f32_dpp v63, v63, v63 row_ror:4 row_mask:0xf bank_mask:0xf
    v_add_f32_dpp v56, v56, v56 row_ror:8 row_mask:0xf bank_mask:0xf
    v_add_f32_dpp v57, v57, v57 row_ror:8 row_mask:0xf bank_mask:0xf
    v_add_f32_dpp v58, v58, v58 row_ror:8 row_mask:0xf bank_mask:0xf
    v_add_f32_dpp v59, v59, v59 row_ror:8 row_mask:0xf bank_mask:0xf
    v_add_f32_dpp v60, v60, v60 row_ror:8 row_mask:0xf bank_mask:0xf
    v_add_f32_dpp v61, v61, v61 row_ror:8 row_mask:0xf bank_mask:0xf
    v_add_f32_dpp v62, v62, v62 row_ror:8 row_mask:0xf bank_mask:0xf
    v_add_f32_dpp v63, v63, v63 row_ror:8 row_mask:0xf bank_mask:0xf
    s_mov_b32 exec_lo, 0x000f000f
    s_mov_b32 exec_hi, 0x000f000f
    v_cvt_pk_bf16_f32 v28, v56, v57
    v_cvt_pk_bf16_f32 v29, v58, v59
    v_cvt_pk_bf16_f32 v30, v60, v61
    v_cvt_pk_bf16_f32 v31, v62, v63
    buffer_store_dwordx4 v[28:31], v24, s[40:43], s70 offen sc1
    v_add3_u32 v32, v28, v29, s11
    v_add3_u32 v32, v30, v31, v32
    ds_write_b32 v34, v32
    s_mov_b64 exec, 1
    ds_add_u32 v4, v5 offset:44
    s_mov_b64 exec, -1
L_p_qd:
    s_cmp_lg_u32 s12, 3
    s_cbranch_scc1 MD_11
    s_lshl_b32 s64, s4, 12
    s_add_u32 s64, s64, 229376
    s_getreg_b32 s71, hwreg(HW_REG_XCC_ID, 0, 4)
    v_lshlrev_b32 v34, 7, v1
    s_mov_b32 s15, 0
FW_12:
    ds_read_b32 v6, v4 offset:28
    s_add_u32 s15, s15, 1
    s_cmp_gt_u32 s15, 1600000
    s_cbranch_scc1 FX_13
    s_waitcnt lgkmcnt(0)
    v_readfirstlane_b32 s14, v6
    s_cmp_lt_u32 s14, 2
    s_cbranch_scc1 FW_12
FX_13:
    s_mov_b32 exec_hi, 0
    s_mov_b32 s61, 0
PL_14:
    buffer_load_dword v35, v34, s[40:43], s64 offen sc1
    s_waitcnt vmcnt(0)
    v_subrev_u32 v35, s11, v35
    v_cmp_lt_u32 s[62:63], 15, v35
    s_cmp_eq_u64 s[62:63], 0
    s_cbranch_scc1 PX_15
    s_add_u32 s61, s61, 1
    s_cmp_lt_u32 s61, 200000
    s_cbranch_scc1 PL_14
PX_15:
    v_cmp_ne_u32 vcc, s71, v35
    s_cmp_eq_u64 vcc, 0
    s_cselect_b32 s13, 1, 2
    v_mov_b32 v35, s13
    ds_write_b32 v4, v35 offset:56
    s_mov_b64 exec, -1
MD_11:
    s_mov_b32 s15, 0
FW_16:
    ds_read_b32 v6, v4 offset:56
    s_add_u32 s15, s15, 1
    s_cmp_gt_u32 s15, 1600000
    s_cbranch_scc1 FX_17
    s_waitcnt lgkmcnt(0)
    v_readfirstlane_b32 s14, v6
    s_cmp_lt_u32 s14, 1
    s_cbranch_scc1 FW_16
FX_17:
    s_cmp_eq_u32 s14, 1
    s_cbranch_scc1 ND_10
    s_cmp_ge_u32 s12, 2
    s_cbranch_scc1 QD_18
    s_mov_b32 exec_lo, 0x000f000f
    s_mov_b32 exec_hi, 0x000f000f
    buffer_store_dwordx4 v[16:19], v15, s[56:59], s65 offen sc1
    buffer_store_dword v20, v14, s[56:59], s66 offen sc1
    s_mov_b64 exec, -1
QD_18:
ND_10:
    s_mov_b32 s59, s14
    s_nop 1
    v_lshrrev_b32 v10, 2, v1
    v_and_b32 v10, 3, v10
    v_and_b32 v11, 3, v1
    v_lshrrev_b32 v12, 1, v10
    v_and_b32 v13, 2, v3
    v_or_b32 v12, v12, v13
    v_and_b32 v13, 1, v3
    v_lshl_or_b32 v12, v13, 2, v12
    v_xor_b32 v12, v12, v11
    v_lshlrev_b32 v12, 4, v12
    v_lshl_or_b32 v13, v13, 2, v10
    v_lshl_add_u32 v12, v13, 7, v12
    v_lshrrev_b32 v13, 1, v3
    v_lshl_add_u32 v12, v13, 10, v12
    v_and_b32 v13, 1, v11
    v_lshl_add_u32 v12, v13, 3, v12
    s_lshl_b32 s13, s12, 12
    v_add_u32 v20, s13, v12
    v_xor_b32 v21, 8, v20
    v_xor_b32 v22, 64, v20
    v_xor_b32 v23, 0x48, v20
    v_add_u32 v24, 0x10000, v20
    v_add_u32 v25, 0x10000, v21
    v_add_u32 v26, 0x10000, v22
    v_add_u32 v27, 0x10000, v23
    v_lshlrev_b32 v28, 4, v1
    v_lshlrev_b32 v33, 2, v1
    s_lshl2_add_u32 s13, s9, s12
    s_lshl3_add_u32 s13, s8, s13
    s_lshl_b32 s65, s13, 12
    s_add_u32 s65, s65, 262144
    s_lshl_b32 s66, s13, 10
    s_add_u32 s66, s66, 196608
    s_lshl2_add_u32 s13, s12, 0
    s_lshl_b32 s14, s13, 4
    v_xor_b32 v29, s14, v28
    s_lshl_b32 s13, s13, 10
    s_add_u32 s13, s13, 131072
    v_add_u32 v29, s13, v29
    s_lshl2_add_u32 s13, s12, 1
    s_lshl_b32 s14, s13, 4
    v_xor_b32 v30, s14, v28
    s_lshl_b32 s13, s13, 10
    s_add_u32 s13, s13, 131072
    v_add_u32 v30, s13, v30
    s_lshl2_add_u32 s13, s12, 2
    s_lshl_b32 s14, s13, 4
    v_xor_b32 v31, s14, v28
    s_lshl_b32 s13, s13, 10
    s_add_u32 s13, s13, 131072
    v_add_u32 v31, s13, v31
    s_lshl2_add_u32 s13, s12, 3
    s_lshl_b32 s14, s13, 4
    v_xor_b32 v32, s14, v28
    s_lshl_b32 s13, s13, 10
    s_add_u32 s13, s13, 131072
    v_add_u32 v32, s13, v32
    s_mov_b32 s72, 0
    s_mov_b32 s73, s5
    s_cmp_lt_u32 s5, 20
    s_cbranch_scc1 RD_21
    s_sub_u32 s13, s5, 20
    s_cmp_ge_u32 s4, 2
    s_cbranch_scc1 RH_22
    s_lshl3_add_u32 s73, s4, s13
    s_cmp_lt_u32 s13, 8
    s_cbranch_scc1 R7_20
    s_lshl2_add_u32 s73, s4, s13
    s_sub_u32 s73, s73, 8
    s_branch R6_19
RH_22:
    s_lshl2_add_u32 s73, s4, s13
    s_add_u32 s73, s73, 8
    s_cmp_lt_u32 s13, 4
    s_cbranch_scc1 R7_20
    s_lshl3_add_u32 s73, s4, s13
    s_sub_u32 s73, s73, 12
R6_19:
    s_mov_b32 s72, 1
    s_cmp_lt_u32 s73, 54
    s_cbranch_scc1 RD_21
    s_mov_b32 s72, 3
    s_branch RD_21
R7_20:
    s_mov_b32 s72, 2
RD_21:
    s_mov_b32 s15, 0
FW_24:
    ds_read_b32 v6, v4 offset:52
    s_add_u32 s15, s15, 1
    s_cmp_gt_u32 s15, 1600000
    s_cbranch_scc1 FX_25
    s_waitcnt lgkmcnt(0)
    v_readfirstlane_b32 s14, v6
    s_cmp_lt_u32 s14, 4
    s_cbranch_scc1 FW_24
FX_25:
    buffer_load_dwordx4 v[64:67], v28, s[40:43], s65 offen offset:0 sc1
    buffer_load_dwordx4 v[68:71], v28, s[40:43], s65 offen offset:1024 sc1
    buffer_load_dwordx4 v[72:75], v28, s[40:43], s65 offen offset:2048 sc1
    buffer_load_dwordx4 v[76:79], v28, s[40:43], s65 offen offset:3072 sc1
    buffer_load_dword v80, v33, s[40:43], s66 offen offset:0 sc1
    buffer_load_dword v81, v33, s[40:43], s66 offen offset:256 sc1
    buffer_load_dword v82, v33, s[40:43], s66 offen offset:512 sc1
    buffer_load_dword v83, v33, s[40:43], s66 offen offset:768 sc1
    s_mov_b32 s15, 0
FW_26:
    ds_read_b32 v6, v4 offset:12
    s_add_u32 s15, s15, 1
    s_cmp_gt_u32 s15, 1600000
    s_cbranch_scc1 FX_27
    s_waitcnt lgkmcnt(0)
    v_readfirstlane_b32 s14, v6
    s_cmp_lt_u32 s14, 4
    s_cbranch_scc1 FW_26
FX_27:
    ds_read_b64_tr_b16 v[128:129], v20 offset:0
    ds_read_b64_tr_b16 v[144:145], v21 offset:0
    ds_read_b64_tr_b16 v[160:161], v22 offset:0
    ds_read_b64_tr_b16 v[176:177], v23 offset:0
    ds_read_b64_tr_b16 v[192:193], v20 offset:2048
    ds_read_b64_tr_b16 v[208:209], v21 offset:2048
    ds_read_b64_tr_b16 v[224:225], v22 offset:2048
    ds_read_b64_tr_b16 v[240:241], v23 offset:2048
    ds_read_b64_tr_b16 v[132:133], v20 offset:32768
    ds_read_b64_tr_b16 v[148:149], v21 offset:32768
    ds_read_b64_tr_b16 v[164:165], v22 offset:32768
    ds_read_b64_tr_b16 v[180:181], v23 offset:32768
    ds_read_b64_tr_b16 v[196:197], v20 offset:34816
    ds_read_b64_tr_b16 v[212:213], v21 offset:34816
    ds_read_b64_tr_b16 v[228:229], v22 offset:34816
    ds_read_b64_tr_b16 v[244:245], v23 offset:34816
    ds_read_b64_tr_b16 v[136:137], v24 offset:0
    ds_read_b64_tr_b16 v[152:153], v25 offset:0
    ds_read_b64_tr_b16 v[168:169], v26 offset:0
    ds_read_b64_tr_b16 v[184:185], v27 offset:0
    ds_read_b64_tr_b16 v[200:201], v24 offset:2048
    ds_read_b64_tr_b16 v[216:217], v25 offset:2048
    ds_read_b64_tr_b16 v[232:233], v26 offset:2048
    ds_read_b64_tr_b16 v[248:249], v27 offset:2048
    ds_read_b64_tr_b16 v[140:141], v24 offset:32768
    ds_read_b64_tr_b16 v[156:157], v25 offset:32768
    ds_read_b64_tr_b16 v[172:173], v26 offset:32768
    ds_read_b64_tr_b16 v[188:189], v27 offset:32768
    ds_read_b64_tr_b16 v[204:205], v24 offset:34816
    ds_read_b64_tr_b16 v[220:221], v25 offset:34816
    ds_read_b64_tr_b16 v[236:237], v26 offset:34816
    ds_read_b64_tr_b16 v[252:253], v27 offset:34816
    s_waitcnt lgkmcnt(0)
    s_mov_b64 exec, 1
    ds_add_u32 v4, v5 offset:20
    s_mov_b64 exec, -1
    s_mov_b32 s61, 0
    s_branch GB_23
PL_28:
    s_mov_b64 exec, s[62:63]
    buffer_load_dwordx4 v[64:67], v28, s[40:43], s65 offen offset:0 sc1
    buffer_load_dwordx4 v[68:71], v28, s[40:43], s65 offen offset:1024 sc1
    buffer_load_dwordx4 v[72:75], v28, s[40:43], s65 offen offset:2048 sc1
    buffer_load_dwordx4 v[76:79], v28, s[40:43], s65 offen offset:3072 sc1
    buffer_load_dword v80, v33, s[40:43], s66 offen offset:0 sc1
    buffer_load_dword v81, v33, s[40:43], s66 offen offset:256 sc1
    buffer_load_dword v82, v33, s[40:43], s66 offen offset:512 sc1
    buffer_load_dword v83, v33, s[40:43], s66 offen offset:768 sc1
    s_mov_b64 exec, -1
GB_23:
    s_waitcnt vmcnt(0)
    v_add3_u32 v7, v64, v65, s11
    v_add3_u32 v7, v66, v67, v7
    v_cmp_ne_u32 s[62:63], v7, v80
    v_add3_u32 v7, v68, v69, s11
    v_add3_u32 v7, v70, v71, v7
    v_cmp_ne_u32 vcc, v7, v81
    s_or_b64 s[62:63], s[62:63], vcc
    v_add3_u32 v7, v72, v73, s11
    v_add3_u32 v7, v74, v75, v7
    v_cmp_ne_u32 vcc, v7, v82
    s_or_b64 s[62:63], s[62:63], vcc
    v_add3_u32 v7, v76, v77, s11
    v_add3_u32 v7, v78, v79, v7
    v_cmp_ne_u32 vcc, v7, v83
    s_or_b64 s[62:63], s[62:63], vcc
    s_cmp_eq_u64 s[62:63], 0
    s_cbranch_scc1 PX_29
    s_add_u32 s61, s61, 1
    s_cmp_lt_u32 s61, 200000
    s_cbranch_scc1 PL_28
PX_29:
    s_mov_b32 s15, 0
FW_30:
    ds_read_b32 v6, v4 offset:28
    s_add_u32 s15, s15, 1
    s_cmp_gt_u32 s15, 1600000
    s_cbranch_scc1 FX_31
    s_waitcnt lgkmcnt(0)
    v_readfirstlane_b32 s14, v6
    s_cmp_lt_u32 s14, 2
    s_cbranch_scc1 FW_30
FX_31:
    ds_write_b128 v29, v[64:67]
    ds_write_b128 v30, v[68:71]
    ds_write_b128 v31, v[72:75]
    ds_write_b128 v32, v[76:79]
    s_mov_b64 exec, 1
    ds_add_u32 v4, v5 offset:8
    s_mov_b64 exec, -1
    s_setprio 0
    v_lshlrev_b32 v29, 6, v2
    v_lshl_add_u32 v29, v3, 4, v29
    s_lshl2_add_u32 s65, s9, s8
    s_lshl_b32 s65, s65, 5
    s_add_u32 s65, s65, s10
    s_mul_i32 s65, s65, 20736
    s_add_u32 s65, s65, 2359296
    s_lshl_b32 s13, s12, 10
    s_add_u32 s67, s65, s13
    s_add_u32 s67, s67, 16384
    s_lshl_b32 s13, s12, 12
    s_add_u32 s65, s65, s13
    v_add_u32 v31, 156672, v28
    v_lshlrev_b32 v30, 4, v2
    v_add_u32 v30, 160768, v30
    v_add_u32 v32, 147456, v15
    s_mov_b32 s60, 0x3e0293ee
    s_mov_b32 s48, s24
    s_and_b32 s49, s25, 0xffff
    s_mov_b32 s50, 4194304
    s_mov_b32 s51, 0x20000
    s_lshl_b32 s69, s7, 6
    s_lshl3_add_u32 s69, s12, s69
    s_lshl_b32 s69, s69, 13
    s_lshl_b32 s13, s6, 8
    s_add_u32 s69, s69, s13
    s_lshl_b32 s70, s12, 10
    s_mov_b32 s74, s69
    s_mov_b32 s75, s70
    s_mov_b32 s15, 0
FW_32:
    ds_read_b32 v6, v4 offset:20
    s_add_u32 s15, s15, 1
    s_cmp_gt_u32 s15, 1600000
    s_cbranch_scc1 FX_33
    s_waitcnt lgkmcnt(0)
    v_readfirstlane_b32 s14, v6
    s_cmp_lt_u32 s14, 4
    s_cbranch_scc1 FW_32
FX_33:
    s_mov_b32 s15, 0
FW_34:
    ds_read_b32 v6, v4 offset:4
    s_add_u32 s15, s15, 1
    s_cmp_gt_u32 s15, 1600000
    s_cbranch_scc1 FX_35
    s_waitcnt lgkmcnt(0)
    v_readfirstlane_b32 s14, v6
    s_cmp_lt_u32 s14, 4
    s_cbranch_scc1 FW_34
FX_35:
    s_cmp_lg_u32 s72, 0
    s_cbranch_scc1 PT_36
    v_lshlrev_b32 v116, 2, v2
    s_mul_i32 s13, s12, 1280
    s_lshl_b32 s14, s73, 6
    s_add_u32 s13, s13, s14
    buffer_load_dword v120, v116, s[44:47], s13 offen
    s_mul_i32 s13, s4, 20
    s_add_u32 s13, s13, s73
    s_mul_i32 s13, s13, 384
    s_lshl_b32 s14, s12, 7
    s_min_u32 s14, s14, 256
    s_add_u32 s13, s13, s14
    s_add_u32 s13, s13, 458752
    buffer_load_dword v121, v116, s[40:43], s13 offen sc1
PT_36:
    s_mov_b32 s70, 0
    s_lshl_b32 s71, s12, 10
    s_add_u32 s71, s71, 32768
    s_mov_b32 s44, s26
    s_and_b32 s45, s27, 0xffff
    s_mov_b32 s46, 5242880
    s_mov_b32 s47, 0x20000
    v_lshrrev_b32 v119, 3, v1
    v_mul_u32_u24 v119, 1280, v119
    v_and_b32 v7, 0x70, v9
    v_add_u32 v119, v119, v7
    s_and_b32 s13, s73, 1
    s_lshl1_add_u32 s13, s4, s13
    s_lshl_b32 s13, s13, 5
    s_add_u32 s13, s13, s12
    s_mul_i32 s68, s13, 10240
    s_lshr_b32 s13, s73, 1
    s_lshl_b32 s13, s13, 7
    s_add_u32 s68, s68, s13
    s_mov_b32 s69, 40960
    s_cmp_ge_u32 s72, 2
    s_cbranch_scc1 EE_37
    s_mov_b32 s70, 4
    s_cmp_eq_u32 s72, 0
    s_cbranch_scc1 EE_37
    s_mov_b32 s44, s30
    s_and_b32 s45, s31, 0xffff
    s_mov_b32 s46, 2211840
    s_mov_b32 s47, 0x20000
    v_lshrrev_b32 v119, 2, v1
    v_mul_u32_u24 v119, 3456, v119
    v_and_b32 v7, 3, v1
    v_lshl_add_u32 v119, v7, 4, v119
    s_mul_i32 s68, s12, 55296
    s_lshl_b32 s13, s73, 6
    s_add_u32 s68, s68, s13
    s_mov_b32 s69, 221184
    s_mov_b32 s70, 2
EE_37:
    s_mov_b32 s13, s70
    s_cmp_eq_u32 s70, 0
    s_cbranch_scc1 EX_39
ED_38:
    s_mov_b32 m0, s71
    s_add_u32 s71, s71, 4096
    buffer_load_dwordx4 v119, s[44:47], s68 offen nt lds
    s_add_u32 s68, s68, s69
    s_sub_u32 s13, s13, 1
    s_cmp_lg_u32 s13, 0
    s_cbranch_scc1 ED_38
EX_39:
    s_lshl_b32 s13, s12, 2
    v_add_u32 v4, s13, v4
    s_mov_b32 s15, 0
FW_40:
    ds_read_b32 v6, v4 offset:64
    s_add_u32 s15, s15, 1
    s_cmp_gt_u32 s15, 1600000
    s_cbranch_scc1 FX_41
    s_waitcnt lgkmcnt(0)
    v_readfirstlane_b32 s14, v6
    s_cmp_lt_u32 s14, 16843009
    s_cbranch_scc1 FW_40
FX_41:
    v_subrev_u32 v4, s13, v4
    ds_read_b64_tr_b16 v[130:131], v20 offset:16384
    ds_read_b64_tr_b16 v[146:147], v21 offset:16384
    ds_read_b64_tr_b16 v[162:163], v22 offset:16384
    ds_read_b64_tr_b16 v[178:179], v23 offset:16384
    ds_read_b64_tr_b16 v[194:195], v20 offset:18432
    ds_read_b64_tr_b16 v[210:211], v21 offset:18432
    ds_read_b64_tr_b16 v[226:227], v22 offset:18432
    ds_read_b64_tr_b16 v[242:243], v23 offset:18432
    ds_read_b64_tr_b16 v[134:135], v20 offset:49152
    ds_read_b64_tr_b16 v[150:151], v21 offset:49152
    ds_read_b64_tr_b16 v[166:167], v22 offset:49152
    ds_read_b64_tr_b16 v[182:183], v23 offset:49152
    ds_read_b64_tr_b16 v[198:199], v20 offset:51200
    ds_read_b64_tr_b16 v[214:215], v21 offset:51200
    ds_read_b64_tr_b16 v[230:231], v22 offset:51200
    ds_read_b64_tr_b16 v[246:247], v23 offset:51200
    ds_read_b64_tr_b16 v[138:139], v24 offset:16384
    ds_read_b64_tr_b16 v[154:155], v25 offset:16384
    ds_read_b64_tr_b16 v[170:171], v26 offset:16384
    ds_read_b64_tr_b16 v[186:187], v27 offset:16384
    ds_read_b64_tr_b16 v[202:203], v24 offset:18432
    ds_read_b64_tr_b16 v[218:219], v25 offset:18432
    ds_read_b64_tr_b16 v[234:235], v26 offset:18432
    ds_read_b64_tr_b16 v[250:251], v27 offset:18432
    ds_read_b64_tr_b16 v[142:143], v24 offset:49152
    ds_read_b64_tr_b16 v[158:159], v25 offset:49152
    ds_read_b64_tr_b16 v[174:175], v26 offset:49152
    ds_read_b64_tr_b16 v[190:191], v27 offset:49152
    ds_read_b64_tr_b16 v[206:207], v24 offset:51200
    ds_read_b64_tr_b16 v[222:223], v25 offset:51200
    ds_read_b64_tr_b16 v[238:239], v26 offset:51200
    ds_read_b64_tr_b16 v[254:255], v27 offset:51200
    s_waitcnt lgkmcnt(0)
    s_setprio 3
    s_barrier
    ds_read_b128 v[36:39], v31 offset:0
    ds_read_b128 v[40:43], v31 offset:1024
    ds_read_b128 v[44:47], v31 offset:2048
    ds_read_b128 v[48:51], v31 offset:3072
    ds_read_b128 v[52:55], v30
    ds_read_b128 v[56:59], v32
    s_waitcnt lgkmcnt(5)
    v_mfma_f32_16x16x32_bf16 v[64:67], v[128:131], v[36:39], 0
    v_mfma_f32_16x16x32_bf16 v[68:71], v[144:147], v[36:39], 0
    s_waitcnt lgkmcnt(4)
    v_mfma_f32_16x16x32_bf16 v[64:67], v[132:135], v[40:43], v[64:67]
    v_mfma_f32_16x16x32_bf16 v[68:71], v[148:151], v[40:43], v[68:71]
    s_waitcnt lgkmcnt(3)
    v_mfma_f32_16x16x32_bf16 v[64:67], v[136:139], v[44:47], v[64:67]
    v_mfma_f32_16x16x32_bf16 v[68:71], v[152:155], v[44:47], v[68:71]
    s_waitcnt lgkmcnt(0)
    v_max3_f32 v112, v52, v53, v54
    s_waitcnt lgkmcnt(2)
    v_mfma_f32_16x16x32_bf16 v[64:67], v[140:143], v[48:51], v[64:67]
    v_add_f32 v56, v56, v57
    v_add_f32 v58, v58, v59
    v_mfma_f32_16x16x32_bf16 v[68:71], v[156:159], v[48:51], v[68:71]
    v_max_f32 v112, v112, v55
    v_add_f32 v113, v56, v58
    v_mfma_f32_16x16x32_bf16 v[72:75], v[160:163], v[36:39], 0
    v_mul_f32 v112, s60, v112
    v_mov_b32 v56, v113
    v_mfma_f32_16x16x32_bf16 v[76:79], v[176:179], v[36:39], 0
    s_nop 0
    v_permlane16_swap_b32 v113, v56
    v_mfma_f32_16x16x32_bf16 v[72:75], v[164:167], v[40:43], v[72:75]
    s_nop 0
    v_add_f32 v113, v113, v56
    v_mfma_f32_16x16x32_bf16 v[76:79], v[180:183], v[40:43], v[76:79]
    v_mov_b32 v56, v113
    s_nop 1
    v_mfma_f32_16x16x32_bf16 v[72:75], v[168:171], v[44:47], v[72:75]
    v_permlane32_swap_b32 v113, v56
    s_nop 0
    v_mfma_f32_16x16x32_bf16 v[76:79], v[184:187], v[44:47], v[76:79]
    v_add_f32 v113, v113, v56
    v_add3_u32 v60, v112, v113, s11
    v_mfma_f32_16x16x32_bf16 v[72:75], v[172:175], v[48:51], v[72:75]
    v_cvt_pk_bf16_f32 v96, v64, v65
    v_cvt_pk_bf16_f32 v97, v66, v67
    v_mfma_f32_16x16x32_bf16 v[76:79], v[188:191], v[48:51], v[76:79]
    v_cvt_pk_bf16_f32 v98, v68, v69
    v_cvt_pk_bf16_f32 v99, v70, v71
    v_mfma_f32_16x16x32_bf16 v[80:83], v[192:195], v[36:39], 0
    buffer_store_dwordx4 v[96:99], v29, s[40:43], s65 offen offset:0 sc1
    v_mfma_f32_16x16x32_bf16 v[84:87], v[208:211], v[36:39], 0
    v_add3_u32 v114, v96, v97, v60
    v_add3_u32 v114, v98, v99, v114
    v_mfma_f32_16x16x32_bf16 v[80:83], v[196:199], v[40:43], v[80:83]
    v_mfma_f32_16x16x32_bf16 v[84:87], v[212:215], v[40:43], v[84:87]
    v_mfma_f32_16x16x32_bf16 v[80:83], v[200:203], v[44:47], v[80:83]
    v_cvt_pk_bf16_f32 v100, v72, v73
    v_cvt_pk_bf16_f32 v101, v74, v75
    v_mfma_f32_16x16x32_bf16 v[84:87], v[216:219], v[44:47], v[84:87]
    v_cvt_pk_bf16_f32 v102, v76, v77
    v_cvt_pk_bf16_f32 v103, v78, v79
    v_mfma_f32_16x16x32_bf16 v[80:83], v[204:207], v[48:51], v[80:83]
    buffer_store_dwordx4 v[100:103], v29, s[40:43], s65 offen offset:1024 sc1
    v_mfma_f32_16x16x32_bf16 v[84:87], v[220:223], v[48:51], v[84:87]
    v_add3_u32 v114, v100, v101, v114
    v_add3_u32 v114, v102, v103, v114
    v_mfma_f32_16x16x32_bf16 v[88:91], v[224:227], v[36:39], 0
    v_mfma_f32_16x16x32_bf16 v[92:95], v[240:243], v[36:39], 0
    v_mfma_f32_16x16x32_bf16 v[88:91], v[228:231], v[40:43], v[88:91]
    v_mfma_f32_16x16x32_bf16 v[92:95], v[244:247], v[40:43], v[92:95]
    v_mfma_f32_16x16x32_bf16 v[88:91], v[232:235], v[44:47], v[88:91]
    v_cvt_pk_bf16_f32 v104, v80, v81
    v_cvt_pk_bf16_f32 v105, v82, v83
    v_mfma_f32_16x16x32_bf16 v[92:95], v[248:251], v[44:47], v[92:95]
    v_cvt_pk_bf16_f32 v106, v84, v85
    v_cvt_pk_bf16_f32 v107, v86, v87
    v_mfma_f32_16x16x32_bf16 v[88:91], v[236:239], v[48:51], v[88:91]
    buffer_store_dwordx4 v[104:107], v29, s[40:43], s65 offen offset:2048 sc1
    v_mfma_f32_16x16x32_bf16 v[92:95], v[252:255], v[48:51], v[92:95]
    v_add3_u32 v115, v104, v105, v60
    v_add3_u32 v115, v106, v107, v115
    s_nop 3
    v_cvt_pk_bf16_f32 v108, v88, v89
    v_cvt_pk_bf16_f32 v109, v90, v91
    v_cvt_pk_bf16_f32 v110, v92, v93
    v_cvt_pk_bf16_f32 v111, v94, v95
    buffer_store_dwordx4 v[108:111], v29, s[40:43], s65 offen offset:3072 sc1
    v_add3_u32 v115, v108, v109, v115
    v_add3_u32 v115, v110, v111, v115
    buffer_store_dwordx4 v[112:115], v15, s[40:43], s67 offen sc1
    s_waitcnt vmcnt(5)
    s_add_u32 m0, s75, 0
    s_add_u32 s13, s74, 0
    buffer_load_dwordx4 v9, s[48:51], s13 offen nt lds
    s_add_u32 m0, s75, 8192
    s_add_u32 s13, s74, 128
    buffer_load_dwordx4 v9, s[48:51], s13 offen nt lds
    s_add_u32 m0, s75, 4096
    s_add_u32 s13, s74, 262144
    buffer_load_dwordx4 v9, s[48:51], s13 offen nt lds
    s_add_u32 m0, s75, 12288
    s_add_u32 s13, s74, 262272
    buffer_load_dwordx4 v9, s[48:51], s13 offen nt lds
    s_mov_b32 s52, s70
    s_mov_b32 s53, s71
    s_branch L_s4
L_s_ckv:
    v_add_u32 v40, s12, v4
    s_cbranch_vccnz GO_42
    s_mov_b32 s15, 0
FW_43:
    ds_read_b32 v6, v4 offset:44
    s_add_u32 s15, s15, 1
    s_cmp_gt_u32 s15, 1600000
    s_cbranch_scc1 FX_44
    s_waitcnt lgkmcnt(0)
    v_readfirstlane_b32 s14, v6
    s_cmp_lt_u32 s14, 4
    s_cbranch_scc1 FW_43
FX_44:
    s_cmp_lg_u32 s12, 0
    s_cbranch_scc1 GO_42
    ds_read_b128 v[20:23], v16
    s_mov_b64 exec, 0xffff
    s_waitcnt vmcnt(0) lgkmcnt(0)
    buffer_store_dwordx4 v[20:23], v17, s[40:43], s69 offen sc1
    s_mov_b64 exec, -1
GO_42:
    s_cbranch_vccz SB_45
    s_waitcnt vmcnt(2)
SB_45:
    s_add_u32 m0, s65, 0
    s_add_u32 s13, s64, 0
    buffer_load_dwordx4 v7, s[44:47], s13 offen lds
    s_cbranch_vccz SB_46
    s_waitcnt vmcnt(2)
SB_46:
    s_add_u32 m0, s65, 1024
    s_add_u32 s13, s64, 0
    buffer_load_dwordx4 v8, s[44:47], s13 offen lds
    s_cbranch_vccz SB_47
    s_waitcnt vmcnt(2)
    s_mov_b64 exec, 1
    ds_add_u32 v4, v5 offset:0
    s_mov_b64 exec, -1
SB_47:
    s_add_u32 m0, s65, 2048
    s_add_u32 s13, s64, 128
    buffer_load_dwordx4 v7, s[44:47], s13 offen lds
    s_cbranch_vccz SB_48
    s_waitcnt vmcnt(2)
SB_48:
    s_add_u32 m0, s65, 3072
    s_add_u32 s13, s64, 128
    buffer_load_dwordx4 v8, s[44:47], s13 offen lds
    s_cbranch_vccz SB_49
    s_waitcnt vmcnt(2)
SB_49:
    s_add_u32 m0, s65, 4096
    s_add_u32 s13, s64, 256
    buffer_load_dwordx4 v7, s[44:47], s13 offen lds
    s_cbranch_vccz SB_50
    s_waitcnt vmcnt(2)
SB_50:
    s_add_u32 m0, s65, 5120
    s_add_u32 s13, s64, 256
    buffer_load_dwordx4 v8, s[44:47], s13 offen lds
    s_cbranch_vccz SB_51
    s_waitcnt vmcnt(2)
SB_51:
    s_add_u32 m0, s65, 6144
    s_add_u32 s13, s64, 384
    buffer_load_dwordx4 v7, s[44:47], s13 offen lds
    s_cbranch_vccz SB_52
    s_waitcnt vmcnt(2)
SB_52:
    s_add_u32 m0, s65, 7168
    s_add_u32 s13, s64, 384
    buffer_load_dwordx4 v8, s[44:47], s13 offen lds
    s_add_u32 m0, s67, 8192
    s_add_u32 s13, s66, 512
    buffer_load_dwordx4 v7, s[44:47], s13 offen lds
    s_waitcnt vmcnt(8)
    s_add_u32 m0, s67, 9216
    s_add_u32 s13, s66, 512
    buffer_load_dwordx4 v8, s[44:47], s13 offen lds
    s_waitcnt vmcnt(8)
    s_add_u32 m0, s67, 10240
    s_add_u32 s13, s66, 640
    buffer_load_dwordx4 v7, s[44:47], s13 offen lds
    ds_read_b128 v[64:67], v11 offset:0
    ds_read_b128 v[68:71], v12 offset:0
    s_waitcnt vmcnt(8)
    s_add_u32 m0, s67, 11264
    s_add_u32 s13, s66, 640
    buffer_load_dwordx4 v8, s[44:47], s13 offen lds
    s_waitcnt vmcnt(8)
    s_add_u32 m0, s67, 12288
    s_add_u32 s13, s66, 768
    buffer_load_dwordx4 v7, s[44:47], s13 offen lds
    ds_read_b128 v[72:75], v11 offset:2048
    ds_read_b128 v[76:79], v12 offset:2048
    s_waitcnt vmcnt(8)
    s_add_u32 m0, s67, 13312
    s_add_u32 s13, s66, 768
    buffer_load_dwordx4 v8, s[44:47], s13 offen lds
    s_waitcnt vmcnt(8)
    s_add_u32 m0, s67, 14336
    s_add_u32 s13, s66, 896
    buffer_load_dwordx4 v7, s[44:47], s13 offen lds
    s_cbranch_vccnz SB_53
    s_mov_b64 exec, 1
    ds_add_u32 v4, v5 offset:52
    s_mov_b64 exec, -1
SB_53:
    ds_read_b128 v[80:83], v11 offset:4096
    ds_read_b128 v[84:87], v12 offset:4096
    s_waitcnt vmcnt(8)
    s_add_u32 m0, s67, 15360
    s_add_u32 s13, s66, 896
    buffer_load_dwordx4 v8, s[44:47], s13 offen lds
    s_waitcnt vmcnt(8)
    s_add_u32 m0, s65, 16384
    s_add_u32 s13, s64, 16384
    buffer_load_dwordx4 v7, s[44:47], s13 offen lds
    ds_read_b128 v[88:91], v11 offset:6144
    ds_read_b128 v[92:95], v12 offset:6144
    s_waitcnt vmcnt(8)
    s_add_u32 m0, s65, 17408
    s_add_u32 s13, s64, 16384
    buffer_load_dwordx4 v8, s[44:47], s13 offen lds
    s_waitcnt vmcnt(8)
    s_add_u32 m0, s65, 18432
    s_add_u32 s13, s64, 16512
    buffer_load_dwordx4 v7, s[44:47], s13 offen lds
    ds_read_b128 v[96:99], v34 offset:0
    ds_read_b128 v[100:103], v35 offset:0
    s_waitcnt vmcnt(8)
    s_add_u32 m0, s65, 19456
    s_add_u32 s13, s64, 16512
    buffer_load_dwordx4 v8, s[44:47], s13 offen lds
    s_waitcnt vmcnt(8)
    s_add_u32 m0, s65, 20480
    s_add_u32 s13, s64, 16640
    buffer_load_dwordx4 v7, s[44:47], s13 offen lds
    ds_read_b128 v[104:107], v34 offset:2048
    ds_read_b128 v[108:111], v35 offset:2048
    s_waitcnt vmcnt(8)
    s_add_u32 m0, s65, 21504
    s_add_u32 s13, s64, 16640
    buffer_load_dwordx4 v8, s[44:47], s13 offen lds
    s_waitcnt vmcnt(8)
    s_add_u32 m0, s65, 22528
    s_add_u32 s13, s64, 16768
    buffer_load_dwordx4 v7, s[44:47], s13 offen lds
    s_cbranch_vccz SB_54
    s_mov_b64 exec, 1
    ds_add_u32 v4, v5 offset:52
    s_mov_b64 exec, -1
SB_54:
    ds_read_b128 v[112:115], v34 offset:4096
    ds_read_b128 v[116:119], v35 offset:4096
    s_waitcnt vmcnt(8)
    s_add_u32 m0, s65, 23552
    s_add_u32 s13, s64, 16768
    buffer_load_dwordx4 v8, s[44:47], s13 offen lds
    s_waitcnt vmcnt(8)
    s_add_u32 m0, s67, 24576
    s_add_u32 s13, s66, 16896
    buffer_load_dwordx4 v7, s[44:47], s13 offen lds
    ds_read_b128 v[120:123], v34 offset:6144
    ds_read_b128 v[124:127], v35 offset:6144
    s_waitcnt lgkmcnt(0)
    s_mul_i32 s11, s11, 1664525
    s_add_u32 s11, s11, 1013904223
    s_mov_b64 exec, 1
    ds_add_u32 v4, v5 offset:12
    s_mov_b64 exec, -1
    s_waitcnt vmcnt(8)
    s_add_u32 m0, s67, 25600
    s_add_u32 s13, s66, 16896
    buffer_load_dwordx4 v8, s[44:47], s13 offen lds
    s_waitcnt vmcnt(8)
    s_add_u32 m0, s67, 26624
    s_add_u32 s13, s66, 17024
    buffer_load_dwordx4 v7, s[44:47], s13 offen lds
    ds_read_b128 v[128:131], v11 offset:16384
    ds_read_b128 v[132:135], v12 offset:16384
    s_waitcnt vmcnt(8)
    s_add_u32 m0, s67, 27648
    s_add_u32 s13, s66, 17024
    buffer_load_dwordx4 v8, s[44:47], s13 offen lds
    s_waitcnt vmcnt(8)
    s_add_u32 m0, s67, 28672
    s_add_u32 s13, s66, 17152
    buffer_load_dwordx4 v7, s[44:47], s13 offen lds
    ds_read_b128 v[136:139], v11 offset:18432
    ds_read_b128 v[140:143], v12 offset:18432
    ds_write_b8 v40, v5 offset:64
    s_waitcnt vmcnt(8)
    s_add_u32 m0, s67, 29696
    s_add_u32 s13, s66, 17152
    buffer_load_dwordx4 v8, s[44:47], s13 offen lds
    s_waitcnt vmcnt(8)
    s_add_u32 m0, s67, 30720
    s_add_u32 s13, s66, 17280
    buffer_load_dwordx4 v7, s[44:47], s13 offen lds
    ds_read_b128 v[144:147], v11 offset:20480
    ds_read_b128 v[148:151], v12 offset:20480
    s_waitcnt vmcnt(8)
    s_add_u32 m0, s67, 31744
    s_add_u32 s13, s66, 17280
    buffer_load_dwordx4 v8, s[44:47], s13 offen lds
    s_mov_b64 exec, 1
    ds_add_u32 v4, v5 offset:4
    s_mov_b64 exec, -1
    v_or_b32 v13, 0, v3
    v_xor_b32 v13, v13, v2
    v_lshlrev_b32 v13, 4, v13
    v_lshl_add_u32 v13, v2, 10, v13
    v_add_u32 v13, 131072, v13
    v_add_u32 v16, s74, v13
    v_subrev_u32 v36, s74, v13
    v_or_b32 v13, 4, v3
    v_xor_b32 v13, v13, v2
    v_lshlrev_b32 v13, 4, v13
    v_lshl_add_u32 v13, v2, 10, v13
    v_add_u32 v13, 131072, v13
    v_add_u32 v17, s74, v13
    v_subrev_u32 v37, s74, v13
    v_or_b32 v13, 8, v3
    v_xor_b32 v13, v13, v2
    v_lshlrev_b32 v13, 4, v13
    v_lshl_add_u32 v13, v2, 10, v13
    v_add_u32 v13, 131072, v13
    v_add_u32 v18, s74, v13
    v_subrev_u32 v38, s74, v13
    v_or_b32 v13, 12, v3
    v_xor_b32 v13, v13, v2
    v_lshlrev_b32 v13, 4, v13
    v_lshl_add_u32 v13, v2, 10, v13
    v_add_u32 v13, 131072, v13
    v_add_u32 v19, s74, v13
    v_subrev_u32 v39, s74, v13
    v_lshlrev_b32 v20, 4, v2
    v_add_u32 v20, 160768, v20
    s_lshl_b32 s13, s12, 2
    v_add_u32 v21, s13, v20
    v_lshlrev_b32 v22, 4, v1
    s_lshl_b32 s13, s12, 10
    s_add_u32 s13, s13, 156672
    v_add_u32 v22, s13, v22
    s_mov_b32 s60, 0x3e0293ee
    v_lshlrev_b32 v23, 6, v2
    v_lshl_add_u32 v23, v3, 2, v23
    s_lshl_b32 s13, s12, 4
    s_add_u32 s13, s13, 147456
    v_add_u32 v23, s13, v23
    s_mov_b32 s72, 0
    s_mov_b32 s73, s5
    s_cmp_lt_u32 s5, 20
    s_cbranch_scc1 RD_57
    s_sub_u32 s13, s5, 20
    s_cmp_ge_u32 s4, 2
    s_cbranch_scc1 RH_58
    s_lshl3_add_u32 s73, s4, s13
    s_cmp_lt_u32 s13, 8
    s_cbranch_scc1 R7_56
    s_lshl2_add_u32 s73, s4, s13
    s_sub_u32 s73, s73, 8
    s_branch R6_55
RH_58:
    s_lshl2_add_u32 s73, s4, s13
    s_add_u32 s73, s73, 8
    s_cmp_lt_u32 s13, 4
    s_cbranch_scc1 R7_56
    s_lshl3_add_u32 s73, s4, s13
    s_sub_u32 s73, s73, 12
R6_55:
    s_mov_b32 s72, 1
    s_cmp_lt_u32 s73, 54
    s_cbranch_scc1 RD_57
    s_mov_b32 s72, 3
    s_branch RD_57
R7_56:
    s_mov_b32 s72, 2
RD_57:
    s_setprio 2
    s_mov_b32 s15, 0
FW_59:
    ds_read_b32 v6, v4 offset:8
    s_add_u32 s15, s15, 1
    s_cmp_gt_u32 s15, 1600000
    s_cbranch_scc1 FX_60
    s_waitcnt lgkmcnt(0)
    v_readfirstlane_b32 s14, v6
    s_cmp_lt_u32 s14, 4
    s_cbranch_scc1 FW_59
FX_60:
    ds_read_b128 v[192:195], v16 offset:0
    ds_read_b128 v[196:199], v17 offset:0
    ds_read_b128 v[200:203], v18 offset:0
    ds_read_b128 v[204:207], v19 offset:0
    ds_read_b128 v[208:211], v16 offset:256
    s_waitcnt lgkmcnt(4)
    v_mfma_f32_16x16x32_bf16 v[56:59], v[64:67], v[192:195], 0
    ds_read_b128 v[212:215], v17 offset:256
    v_mfma_f32_16x16x32_bf16 v[60:63], v[128:131], v[192:195], 0
    s_waitcnt lgkmcnt(4)
    v_mfma_f32_16x16x32_bf16 v[56:59], v[68:71], v[196:199], v[56:59]
    ds_read_b128 v[216:219], v18 offset:256
    v_mfma_f32_16x16x32_bf16 v[60:63], v[132:135], v[196:199], v[60:63]
    s_waitcnt lgkmcnt(4)
    v_mfma_f32_16x16x32_bf16 v[56:59], v[72:75], v[200:203], v[56:59]
    ds_read_b128 v[220:223], v19 offset:256
    v_mfma_f32_16x16x32_bf16 v[60:63], v[136:139], v[200:203], v[60:63]
    s_waitcnt lgkmcnt(4)
    v_mfma_f32_16x16x32_bf16 v[56:59], v[76:79], v[204:207], v[56:59]
    ds_read_b128 v[224:227], v36 offset:512
    v_mfma_f32_16x16x32_bf16 v[60:63], v[140:143], v[204:207], v[60:63]
    s_waitcnt lgkmcnt(4)
    v_mfma_f32_16x16x32_bf16 v[56:59], v[80:83], v[208:211], v[56:59]
    ds_read_b128 v[228:231], v37 offset:512
    v_mfma_f32_16x16x32_bf16 v[60:63], v[144:147], v[208:211], v[60:63]
    s_waitcnt lgkmcnt(4)
    v_mfma_f32_16x16x32_bf16 v[56:59], v[84:87], v[212:215], v[56:59]
    ds_read_b128 v[232:235], v38 offset:512
    v_mfma_f32_16x16x32_bf16 v[60:63], v[148:151], v[212:215], v[60:63]
    s_waitcnt vmcnt(8)
    ds_read_b128 v[152:155], v11 offset:22528
    ds_read_b128 v[156:159], v12 offset:22528
    ds_write_b8 v40, v5 offset:68
    s_waitcnt lgkmcnt(7)
    v_mfma_f32_16x16x32_bf16 v[56:59], v[88:91], v[216:219], v[56:59]
    ds_read_b128 v[236:239], v39 offset:512
    s_waitcnt lgkmcnt(7)
    v_mfma_f32_16x16x32_bf16 v[56:59], v[92:95], v[220:223], v[56:59]
    ds_read_b128 v[240:243], v36 offset:768
    s_waitcnt vmcnt(6)
    ds_read_b128 v[160:163], v34 offset:16384
    ds_read_b128 v[164:167], v35 offset:16384
    s_waitcnt lgkmcnt(9)
    v_mfma_f32_16x16x32_bf16 v[56:59], v[96:99], v[224:227], v[56:59]
    ds_read_b128 v[244:247], v37 offset:768
    s_waitcnt lgkmcnt(9)
    v_mfma_f32_16x16x32_bf16 v[56:59], v[100:103], v[228:231], v[56:59]
    ds_read_b128 v[248:251], v38 offset:768
    s_waitcnt vmcnt(4)
    ds_read_b128 v[168:171], v34 offset:18432
    ds_read_b128 v[172:175], v35 offset:18432
    ds_write_b8 v40, v5 offset:72
    s_waitcnt lgkmcnt(10)
    v_mfma_f32_16x16x32_bf16 v[60:63], v[152:155], v[216:219], v[60:63]
    v_mfma_f32_16x16x32_bf16 v[60:63], v[156:159], v[220:223], v[60:63]
    s_waitcnt lgkmcnt(12)
    v_mfma_f32_16x16x32_bf16 v[56:59], v[104:107], v[232:235], v[56:59]
    ds_read_b128 v[252:255], v39 offset:768
    s_waitcnt lgkmcnt(9)
    v_mfma_f32_16x16x32_bf16 v[56:59], v[108:111], v[236:239], v[56:59]
    s_waitcnt vmcnt(2)
    ds_read_b128 v[176:179], v34 offset:20480
    ds_read_b128 v[180:183], v35 offset:20480
    s_waitcnt lgkmcnt(8)
    v_mfma_f32_16x16x32_bf16 v[60:63], v[160:163], v[224:227], v[60:63]
    v_mfma_f32_16x16x32_bf16 v[60:63], v[164:167], v[228:231], v[60:63]
    s_waitcnt lgkmcnt(10)
    v_mfma_f32_16x16x32_bf16 v[56:59], v[112:115], v[240:243], v[56:59]
    s_waitcnt lgkmcnt(7)
    v_mfma_f32_16x16x32_bf16 v[56:59], v[116:119], v[244:247], v[56:59]
    s_waitcnt lgkmcnt(4)
    v_mfma_f32_16x16x32_bf16 v[60:63], v[168:171], v[232:235], v[60:63]
    v_mfma_f32_16x16x32_bf16 v[60:63], v[172:175], v[236:239], v[60:63]
    s_waitcnt vmcnt(0)
    ds_read_b128 v[184:187], v34 offset:22528
    ds_read_b128 v[188:191], v35 offset:22528
    ds_write_b8 v40, v5 offset:76
    s_waitcnt lgkmcnt(9)
    v_mfma_f32_16x16x32_bf16 v[56:59], v[120:123], v[248:251], v[56:59]
    s_waitcnt lgkmcnt(5)
    v_mfma_f32_16x16x32_bf16 v[56:59], v[124:127], v[252:255], v[56:59]
    s_waitcnt lgkmcnt(3)
    v_mfma_f32_16x16x32_bf16 v[60:63], v[176:179], v[240:243], v[60:63]
    v_mfma_f32_16x16x32_bf16 v[60:63], v[180:183], v[244:247], v[60:63]
    s_waitcnt lgkmcnt(1)
    v_mfma_f32_16x16x32_bf16 v[60:63], v[184:187], v[248:251], v[60:63]
    v_mfma_f32_16x16x32_bf16 v[60:63], v[188:191], v[252:255], v[60:63]
    s_nop 5
L_s_max:
    v_max3_f32 v24, v56, v57, v58
    v_max_f32 v24, v24, v59
    v_max3_f32 v24, v24, v60, v61
    v_max3_f32 v24, v24, v62, v63
    v_mov_b32 v25, v24
    s_nop 1
    v_permlane16_swap_b32 v24, v25
    s_nop 0
    v_max_f32 v24, v24, v25
    v_mov_b32 v25, v24
    s_nop 1
    v_permlane32_swap_b32 v24, v25
    s_nop 0
    v_max_f32 v24, v24, v25
    ds_write_b32 v21, v24
    s_mov_b32 s15, 0
MX_61:
    ds_read_b128 v[24:27], v20
    s_add_u32 s15, s15, 1
    s_cmp_gt_u32 s15, 1600000
    s_cbranch_scc1 MZ_62
    s_waitcnt lgkmcnt(0)
    v_max3_u32 v28, v24, v25, v26
    v_max_u32 v28, v28, v27
    v_cmp_eq_u32 vcc, -1, v28
    s_cbranch_vccnz MX_61
MZ_62:
    s_waitcnt lgkmcnt(0)
    v_max3_f32 v24, v24, v25, v26
    v_max_f32 v24, v24, v27
    v_mul_f32 v24, s60, v24
    v_fma_f32 v56, v56, s60, -v24
    v_fma_f32 v57, v57, s60, -v24
    v_fma_f32 v58, v58, s60, -v24
    v_fma_f32 v59, v59, s60, -v24
    v_fma_f32 v60, v60, s60, -v24
    v_fma_f32 v61, v61, s60, -v24
    v_fma_f32 v62, v62, s60, -v24
    v_fma_f32 v63, v63, s60, -v24
    v_exp_f32 v56, v56
    v_exp_f32 v57, v57
    v_exp_f32 v58, v58
    v_exp_f32 v59, v59
    v_exp_f32 v60, v60
    v_exp_f32 v61, v61
    v_exp_f32 v62, v62
    v_exp_f32 v63, v63
    s_nop 0
    v_cvt_pk_bf16_f32 v28, v56, v57
    v_cvt_pk_bf16_f32 v29, v58, v59
    v_cvt_pk_bf16_f32 v30, v60, v61
    v_cvt_pk_bf16_f32 v31, v62, v63
    ds_write_b128 v22, v[28:31]
    v_add_f32 v56, v56, v57
    v_add_f32 v58, v58, v59
    v_add_f32 v60, v60, v61
    v_add_f32 v62, v62, v63
    v_add_f32 v56, v56, v58
    v_add_f32 v60, v60, v62
    v_add_f32 v25, v56, v60
    ds_write_b32 v23, v25
    s_waitcnt lgkmcnt(0)
    s_barrier
    s_setprio 0
    s_lshr_b32 s13, s7, 2
    s_lshl1_add_u32 s69, s6, s13
    s_lshl2_add_u32 s69, s69, s12
    s_and_b32 s13, s7, 3
    s_lshl2_add_u32 s69, s69, s13
    s_lshl_b32 s68, s69, 8
    s_lshr_b32 s69, s69, 3
    s_lshl2_add_u32 s69, s69, s13
    s_lshl_b32 s69, s69, 7
    s_and_b32 s13, s12, 1
    s_lshl2_add_u32 s69, s13, s69
    s_add_u32 s68, s68, 524288
    s_add_u32 s69, s69, 393216
    v_lshlrev_b32 v21, 1, v14
    ds_read_b32 v6, v4 offset:56
    s_waitcnt lgkmcnt(0)
    v_readfirstlane_b32 s59, v6
    s_mov_b32 exec_lo, 0x000f000f
    s_mov_b32 exec_hi, 0x000f000f
    buffer_load_dword v120, v15, s[40:43], s68 offen sc1
    buffer_load_dword v121, v21, s[40:43], s69 offen sc1
    s_mov_b64 exec, -1
L_s4:
    s_setprio 0
    s_mov_b32 s13, 20736
    v_lshrrev_b32 v9, 3, v1
    v_mul_lo_u32 v9, v9, s13
    v_and_b32 v10, 3, v1
    v_lshl_add_u32 v9, v10, 4, v9
    v_and_b32 v10, 4, v1
    v_lshl_add_u32 v8, v10, 8, v9
    s_lshr_b32 s14, s6, 4
    s_lshl3_add_u32 s64, s14, s3
    s_mul_i32 s64, s64, 331776
    s_and_b32 s14, s6, 15
    s_lshl_b32 s14, s14, 6
    s_add_u32 s64, s64, s14
    s_lshl_b32 s13, s7, 11
    s_add_u32 s65, s64, s13
    s_add_u32 s65, s65, 2359296
    s_lshr_b32 s13, s7, 1
    s_lshl_b32 s13, s13, 10
    s_add_u32 s66, s64, s13
    s_add_u32 s66, s66, 2375680
    s_add_u32 s74, s65, 165888
    s_add_u32 s75, s66, 165888
    s_bitcmp1_b32 s7, 0
    s_cselect_b64 s[56:57], -1, 0
    v_and_b32 v13, 7, v1
    v_lshlrev_b32 v13, 4, v13
    v_and_b32 v10, 1, v3
    v_lshl_add_u32 v13, v10, 3, v13
    v_lshrrev_b32 v10, 1, v3
    v_lshl_add_u32 v13, v10, 2, v13
    s_and_b32 s13, s3, 1
    s_lshl_b32 s13, s13, 2
    s_lshr_b32 s14, s3, 1
    s_add_u32 s13, s13, s14
    s_lshl_b32 s14, s13, 7
    s_add_u32 s14, s14, 161024
    v_add_u32 v13, s14, v13
    s_lshl_b32 s13, s13, 3
    s_add_u32 s13, s13, 162176
    v_mov_b32 v12, s13
    v_lshrrev_b32 v10, 2, v1
    v_and_b32 v10, 3, v10
    v_and_b32 v11, 1, v3
    v_lshlrev_b32 v11, 2, v11
    v_or_b32 v10, v10, v11
    v_and_b32 v16, 3, v1
    v_xor_b32 v16, v16, v11
    v_lshrrev_b32 v11, 1, v10
    v_xor_b32 v16, v16, v11
    v_lshlrev_b32 v16, 4, v16
    v_lshl_add_u32 v16, v10, 7, v16
    v_lshl_add_u32 v16, v3, 10, v16
    s_and_b32 s13, s12, 1
    s_lshl_b32 s13, s13, 6
    v_xor_b32 v16, s13, v16
    s_lshr_b32 s13, s12, 1
    s_lshl_b32 s13, s13, 13
    s_add_u32 s13, s13, 0
    v_add_u32 v16, s13, v16
    v_xor_b32 v17, 0x220, v16
    v_and_b32 v10, 7, v2
    v_lshlrev_b32 v18, 7, v10
    v_lshl_add_u32 v18, v3, 4, v18
    v_add_u32 v18, 161024, v18
    v_lshlrev_b32 v19, 3, v10
    v_add_u32 v19, 162176, v19
    v_xor_b32 v20, 32, v19
    v_lshlrev_b32 v21, 1, v14
    v_lshrrev_b32 v10, 2, v1
    v_and_b32 v10, 3, v10
    v_and_b32 v11, 1, v3
    v_lshlrev_b32 v11, 2, v11
    v_and_b32 v110, 3, v1
    v_xor_b32 v110, v110, v11
    v_lshrrev_b32 v11, 1, v10
    v_xor_b32 v110, v110, v11
    v_lshlrev_b32 v110, 4, v110
    v_lshl_add_u32 v110, v10, 7, v110
    v_lshl_add_u32 v110, v3, 10, v110
    s_lshr_b32 s13, s3, 2
    s_and_b32 s14, s3, 1
    s_lshl1_add_u32 s13, s13, s14
    s_lshl_b32 s13, s13, 13
    s_add_u32 s13, s13, 32768
    v_add_u32 v110, s13, v110
    v_xor_b32 v111, 0x220, v110
    v_xor_b32 v112, 64, v110
    v_xor_b32 v113, 0x260, v110
    v_and_b32 v106, 3, v2
    v_lshlrev_b32 v106, 7, v106
    v_lshl_add_u32 v106, v3, 5, v106
    v_and_b32 v7, 4, v2
    v_lshl_add_u32 v106, v7, 2, v106
    v_and_b32 v7, 8, v2
    v_lshl_add_u32 v106, v7, 6, v106
    s_lshl_b32 s13, s3, 10
    s_add_u32 s13, s13, 114688
    v_add_u32 v106, s13, v106
    v_lshlrev_b32 v108, 3, v1
    s_lshl_b32 s13, s14, 9
    s_add_u32 s13, s13, 114688
    v_add_u32 v107, s13, v108
    s_and_b32 s13, s73, 1
    s_lshl1_add_u32 s64, s4, s13
    s_lshl3_add_u32 s13, s64, s3
    s_lshl_b32 s70, s13, 11
    s_add_u32 s70, s70, 524288
    s_lshl_b32 s71, s13, 9
    s_add_u32 s71, s71, 393216
    s_and_b32 s13, s73, 0xfe
    s_add_u32 s13, s13, s14
    s_lshl4_add_u32 s60, s13, s64
    s_lshl_b32 s60, s60, 9
    s_lshl_b32 s13, s73, 13
    s_lshl_b32 s14, s12, 7
    s_add_u32 s13, s13, s14
    s_cmp_ge_u32 s3, 4
    s_cselect_b32 s60, s13, s60
    s_add_u32 s60, s60, 786432
    v_lshlrev_b32 v108, 4, v2
    v_lshl_add_u32 v108, v3, 7, v108
    v_and_b32 v109, 7, v1
    v_lshlrev_b32 v109, 4, v109
    v_lshrrev_b32 v7, 3, v1
    v_lshl_add_u32 v109, v7, 9, v109
    s_mul_i32 s67, s4, 5
    s_lshr_b32 s13, s73, 2
    s_add_u32 s67, s67, s13
    s_mul_i32 s67, s67, 1536
    s_add_u32 s67, s67, 458752
    s_waitcnt vmcnt(0)
LT_63:
    s_barrier
    buffer_load_dwordx4 v[36:39], v9, s[40:43], s66 offen sc1
    buffer_load_dwordx4 v[40:43], v9, s[40:43], s75 offen sc1
    buffer_load_dwordx4 v[28:31], v8, s[40:43], s65 offen sc1
    buffer_load_dwordx4 v[32:35], v8, s[40:43], s74 offen sc1
    ds_read_b64_tr_b16 v[64:65], v16 offset:0
    ds_read_b64_tr_b16 v[66:67], v17 offset:0
    ds_read_b64_tr_b16 v[68:69], v16 offset:8
    ds_read_b64_tr_b16 v[70:71], v17 offset:8
    ds_read_b64_tr_b16 v[72:73], v16 offset:4096
    ds_read_b64_tr_b16 v[74:75], v17 offset:4096
    ds_read_b64_tr_b16 v[76:77], v16 offset:4104
    ds_read_b64_tr_b16 v[78:79], v17 offset:4104
    s_cmp_ge_u32 s3, 4
    s_cbranch_scc1 LQ_64
    ds_read_b64_tr_b16 v[128:129], v110 offset:0
    ds_read_b64_tr_b16 v[130:131], v111 offset:0
    ds_read_b64_tr_b16 v[132:133], v110 offset:8
    ds_read_b64_tr_b16 v[134:135], v111 offset:8
    ds_read_b64_tr_b16 v[136:137], v112 offset:0
    ds_read_b64_tr_b16 v[138:139], v113 offset:0
    ds_read_b64_tr_b16 v[140:141], v112 offset:8
    ds_read_b64_tr_b16 v[142:143], v113 offset:8
    ds_read_b64_tr_b16 v[144:145], v110 offset:4096
    ds_read_b64_tr_b16 v[146:147], v111 offset:4096
    ds_read_b64_tr_b16 v[148:149], v110 offset:4104
    ds_read_b64_tr_b16 v[150:151], v111 offset:4104
    ds_read_b64_tr_b16 v[152:153], v112 offset:4096
    ds_read_b64_tr_b16 v[154:155], v113 offset:4096
    ds_read_b64_tr_b16 v[156:157], v112 offset:4104
    ds_read_b64_tr_b16 v[158:159], v113 offset:4104
LQ_64:
    s_mov_b32 s61, 0
    s_branch SK_66
PL_65:
    s_mov_b64 exec, s[62:63]
    buffer_load_dwordx4 v[36:39], v9, s[40:43], s66 offen sc1
    buffer_load_dwordx4 v[40:43], v9, s[40:43], s75 offen sc1
    buffer_load_dwordx4 v[28:31], v8, s[40:43], s65 offen sc1
    buffer_load_dwordx4 v[32:35], v8, s[40:43], s74 offen sc1
    s_mov_b64 exec, -1
SK_66:
    s_waitcnt vmcnt(2)
    v_max_f32 v24, v36, v40
    v_cndmask_b32 v46, v38, v39, s[56:57]
    v_cndmask_b32 v47, v42, v43, s[56:57]
    v_max_f32_dpp v24, v24, v24 row_ror:8 row_mask:0xf bank_mask:0xf
    v_add3_u32 v48, v36, v37, s11
    v_add3_u32 v49, v40, v41, s11
    v_mov_b32 v25, v24
    s_nop 1
    v_permlane16_swap_b32 v24, v25
    s_nop 0
    v_max_f32 v24, v24, v25
    v_mov_b32 v25, v24
    s_nop 1
    v_permlane32_swap_b32 v24, v25
    s_nop 0
    v_max_f32 v24, v24, v25
    v_sub_f32 v26, v36, v24
    v_sub_f32 v27, v40, v24
    v_exp_f32 v26, v26
    v_exp_f32 v27, v27
    v_sub_u32 v46, v46, v48
    v_sub_u32 v47, v47, v49
    v_mul_f32 v25, v26, v37
    v_fmac_f32 v25, v27, v41
    s_waitcnt vmcnt(0)
    v_add3_u32 v48, v28, v29, v30
    v_add3_u32 v49, v32, v33, v34
    v_add_u32 v48, v48, v31
    v_add_u32 v49, v49, v35
    v_add_f32_dpp v25, v25, v25 row_ror:8 row_mask:0xf bank_mask:0xf
    v_add_u32_dpp v44, v48, v48 row_shl:4 row_mask:0xf bank_mask:0x5
    v_add_u32_dpp v45, v49, v49 row_shl:4 row_mask:0xf bank_mask:0x5
    v_add_u32_dpp v44, v48, v48 row_shr:4 row_mask:0xf bank_mask:0xa
    v_add_u32_dpp v45, v49, v49 row_shr:4 row_mask:0xf bank_mask:0xa
    v_cmp_ne_u32 s[62:63], v44, v46
    v_cmp_ne_u32 vcc, v45, v47
    s_or_b64 s[62:63], s[62:63], vcc
    s_cmp_eq_u64 s[62:63], 0
    s_cbranch_scc1 PX_67
    s_add_u32 s61, s61, 1
    s_cmp_lt_u32 s61, 200000
    s_cbranch_scc1 PL_65
PX_67:
    s_cmp_lt_u32 s3, 4
    s_cbranch_scc1 SB_69
    s_cmp_eq_u32 s52, 0
    s_cbranch_scc1 SB_69
SB_68:
    s_mov_b32 m0, s53
    s_add_u32 s53, s53, 4096
    buffer_load_dwordx4 v119, s[44:47], s68 offen nt lds
    s_add_u32 s68, s68, s69
    s_sub_u32 s52, s52, 1
    s_cmp_lg_u32 s52, 0
    s_cbranch_scc1 SB_68
SB_69:
    v_lshlrev_b32 v44, 16, v28
    v_and_b32 v45, 0xffff0000, v28
    v_lshlrev_b32 v52, 16, v32
    v_and_b32 v53, 0xffff0000, v32
    v_lshlrev_b32 v46, 16, v29
    v_and_b32 v47, 0xffff0000, v29
    v_lshlrev_b32 v54, 16, v33
    v_and_b32 v55, 0xffff0000, v33
    v_lshlrev_b32 v48, 16, v30
    v_and_b32 v49, 0xffff0000, v30
    v_lshlrev_b32 v56, 16, v34
    v_and_b32 v57, 0xffff0000, v34
    v_lshlrev_b32 v50, 16, v31
    v_and_b32 v51, 0xffff0000, v31
    v_lshlrev_b32 v58, 16, v35
    v_and_b32 v59, 0xffff0000, v35
    v_mov_b32 v60, v25
    v_pk_mul_f32 v[44:45], v[44:45], v[26:27] op_sel_hi:[1,0]
    v_pk_mul_f32 v[46:47], v[46:47], v[26:27] op_sel_hi:[1,0]
    v_pk_mul_f32 v[48:49], v[48:49], v[26:27] op_sel_hi:[1,0]
    v_pk_mul_f32 v[50:51], v[50:51], v[26:27] op_sel_hi:[1,0]
    v_permlane16_swap_b32 v25, v60
    v_pk_fma_f32 v[44:45], v[52:53], v[26:27], v[44:45] op_sel:[0,1,0] op_sel_hi:[1,1,1]
    v_pk_fma_f32 v[46:47], v[54:55], v[26:27], v[46:47] op_sel:[0,1,0] op_sel_hi:[1,1,1]
    v_pk_fma_f32 v[48:49], v[56:57], v[26:27], v[48:49] op_sel:[0,1,0] op_sel_hi:[1,1,1]
    v_pk_fma_f32 v[50:51], v[58:59], v[26:27], v[50:51] op_sel:[0,1,0] op_sel_hi:[1,1,1]
    v_add_f32 v25, v25, v60
    v_permlane16_swap_b32 v44, v48
    v_permlane16_swap_b32 v45, v49
    v_permlane16_swap_b32 v46, v50
    v_permlane16_swap_b32 v47, v51
    v_mov_b32 v60, v25
    v_add_f32 v44, v44, v48
    v_add_f32 v45, v45, v49
    v_add_f32 v46, v46, v50
    v_add_f32 v47, v47, v51
    v_permlane32_swap_b32 v25, v60
    v_permlane32_swap_b32 v44, v46
    v_permlane32_swap_b32 v45, v47
    v_add_f32 v25, v25, v60
    v_add_f32 v44, v44, v46
    v_add_f32 v45, v45, v47
    ds_write_b64 v12, v[24:25]
    v_add_f32_dpp v44, v44, v44 row_ror:8 row_mask:0xf bank_mask:0xf
    v_add_f32_dpp v45, v45, v45 row_ror:8 row_mask:0xf bank_mask:0xf
    v_cvt_pk_bf16_f32 v44, v44, v45
    ds_write_b32 v13, v44
    s_waitcnt lgkmcnt(0)
    s_barrier
    s_cmp_ge_u32 s3, 4
    s_cbranch_scc1 N4_70
    ds_read_b128 v[24:27], v18
    ds_read_b128 v[28:31], v18 offset:64
    ds_read_b64 v[32:33], v19
    ds_read_b64 v[34:35], v20
    s_waitcnt lgkmcnt(3)
    v_mfma_f32_16x16x32_bf16 v[56:59], v[64:67], v[24:27], 0
    v_mfma_f32_16x16x32_bf16 v[60:63], v[68:71], v[24:27], 0
    s_waitcnt lgkmcnt(2)
    v_mfma_f32_16x16x32_bf16 v[56:59], v[72:75], v[28:31], v[56:59]
    v_mfma_f32_16x16x32_bf16 v[60:63], v[76:79], v[28:31], v[60:63]
    s_waitcnt lgkmcnt(0)
    v_max_f32 v36, v32, v34
    v_sub_f32 v32, v32, v36
    v_sub_f32 v34, v34, v36
    v_exp_f32 v32, v32
    v_exp_f32 v34, v34
    s_nop 0
    v_mul_f32 v33, v33, v32
    v_fmac_f32 v33, v35, v34
    v_rcp_f32 v33, v33
    s_nop 0
    v_mul_f32 v32, v32, v33
    v_pk_mul_f32 v[56:57], v[56:57], v[32:33] op_sel_hi:[1,0]
    v_pk_mul_f32 v[58:59], v[58:59], v[32:33] op_sel_hi:[1,0]
    v_pk_mul_f32 v[60:61], v[60:61], v[32:33] op_sel_hi:[1,0]
    v_pk_mul_f32 v[62:63], v[62:63], v[32:33] op_sel_hi:[1,0]
    v_add_f32_dpp v56, v56, v56 row_ror:4 row_mask:0xf bank_mask:0xf
    v_add_f32_dpp v57, v57, v57 row_ror:4 row_mask:0xf bank_mask:0xf
    v_add_f32_dpp v58, v58, v58 row_ror:4 row_mask:0xf bank_mask:0xf
    v_add_f32_dpp v59, v59, v59 row_ror:4 row_mask:0xf bank_mask:0xf
    v_add_f32_dpp v60, v60, v60 row_ror:4 row_mask:0xf bank_mask:0xf
    v_add_f32_dpp v61, v61, v61 row_ror:4 row_mask:0xf bank_mask:0xf
    v_add_f32_dpp v62, v62, v62 row_ror:4 row_mask:0xf bank_mask:0xf
    v_add_f32_dpp v63, v63, v63 row_ror:4 row_mask:0xf bank_mask:0xf
    s_mov_b32 exec_lo, 0x000f000f
    s_mov_b32 exec_hi, 0x000f000f
    v_cvt_pk_bf16_f32 v24, v56, v57
    v_cvt_pk_bf16_f32 v25, v58, v59
    v_cvt_pk_bf16_f32 v26, v60, v61
    v_cvt_pk_bf16_f32 v27, v62, v63
    v_add3_u32 v28, v24, v25, s11
    v_add3_u32 v28, v26, v27, v28
    s_cmp_lg_u32 s59, 1
    s_cbranch_scc1 LG_71
    buffer_store_dwordx4 v[24:27], v15, s[40:43], s68 offen
    buffer_store_dword v28, v21, s[40:43], s69 offen
    s_branch LE_72
LG_71:
    buffer_store_dwordx4 v[24:27], v15, s[40:43], s68 offen sc1
    buffer_store_dword v28, v21, s[40:43], s69 offen sc1
LE_72:
N4_70:
    s_mov_b64 exec, -1
    s_cmp_eq_u32 s72, 1
    s_cbranch_scc1 L_s6
    s_cmp_eq_u32 s72, 2
    s_cbranch_scc1 L_s7
    s_cmp_eq_u32 s72, 3
    s_cbranch_scc1 L_fin
    s_cmp_lt_u32 s3, 4
    s_cbranch_scc1 LQ_73
    s_waitcnt vmcnt(0)
    s_mov_b64 exec, 1
    ds_add_u32 v4, v5 offset:48
    s_mov_b64 exec, -1
    s_mov_b32 s15, 0
FW_74:
    ds_read_b32 v6, v4 offset:48
    s_add_u32 s15, s15, 1
    s_cmp_gt_u32 s15, 1600000
    s_cbranch_scc1 FX_75
    s_waitcnt lgkmcnt(0)
    v_readfirstlane_b32 s14, v6
    s_cmp_lt_u32 s14, 4
    s_cbranch_scc1 FW_74
FX_75:
    ds_read_b64_tr_b16 v[128:129], v110 offset:0
    ds_read_b64_tr_b16 v[130:131], v111 offset:0
    ds_read_b64_tr_b16 v[132:133], v110 offset:8
    ds_read_b64_tr_b16 v[134:135], v111 offset:8
    ds_read_b64_tr_b16 v[136:137], v112 offset:0
    ds_read_b64_tr_b16 v[138:139], v113 offset:0
    ds_read_b64_tr_b16 v[140:141], v112 offset:8
    ds_read_b64_tr_b16 v[142:143], v113 offset:8
    ds_read_b64_tr_b16 v[144:145], v110 offset:4096
    ds_read_b64_tr_b16 v[146:147], v111 offset:4096
    ds_read_b64_tr_b16 v[148:149], v110 offset:4104
    ds_read_b64_tr_b16 v[150:151], v111 offset:4104
    ds_read_b64_tr_b16 v[152:153], v112 offset:4096
    ds_read_b64_tr_b16 v[154:155], v113 offset:4096
    ds_read_b64_tr_b16 v[156:157], v112 offset:4104
    ds_read_b64_tr_b16 v[158:159], v113 offset:4104
LQ_73:
    s_mov_b64 s[62:63], -1
    s_mov_b32 s61, 0
PL_76:
    s_mov_b64 exec, s[62:63]
    buffer_load_dwordx4 v[96:99], v15, s[40:43], s70 offen sc1
    buffer_load_dwordx4 v[100:103], v15, s[40:43], s70 offen offset:1024 sc1
    buffer_load_dwordx2 v[104:105], v21, s[40:43], s71 offen sc1
    s_mov_b64 exec, -1
    s_waitcnt vmcnt(1) lgkmcnt(0)
    v_mfma_f32_16x16x32_bf16 v[80:83], v[128:131], v[96:99], 0
    v_mfma_f32_16x16x32_bf16 v[84:87], v[132:135], v[96:99], 0
    v_mfma_f32_16x16x32_bf16 v[88:91], v[136:139], v[96:99], 0
    v_mfma_f32_16x16x32_bf16 v[92:95], v[140:143], v[96:99], 0
    v_mfma_f32_16x16x32_bf16 v[80:83], v[144:147], v[100:103], v[80:83]
    v_mfma_f32_16x16x32_bf16 v[84:87], v[148:151], v[100:103], v[84:87]
    v_mfma_f32_16x16x32_bf16 v[88:91], v[152:155], v[100:103], v[88:91]
    v_mfma_f32_16x16x32_bf16 v[92:95], v[156:159], v[100:103], v[92:95]
    s_waitcnt vmcnt(0)
    v_add3_u32 v7, v96, v97, s11
    v_add3_u32 v7, v98, v99, v7
    v_cmp_ne_u32 s[62:63], v7, v104
    v_add3_u32 v7, v100, v101, s11
    v_add3_u32 v7, v102, v103, v7
    v_cmp_ne_u32 vcc, v7, v105
    s_or_b64 s[62:63], s[62:63], vcc
    s_cmp_eq_u64 s[62:63], 0
    s_cbranch_scc1 PX_77
    s_add_u32 s61, s61, 1
    s_cmp_lt_u32 s61, 200000
    s_cbranch_scc1 PL_76
PX_77:
    v_add_f32_dpp v80, v80, v80 row_ror:8 row_mask:0xf bank_mask:0x3
    v_add_f32_dpp v81, v81, v81 row_ror:8 row_mask:0xf bank_mask:0x3
    v_add_f32_dpp v82, v82, v82 row_ror:8 row_mask:0xf bank_mask:0x3
    v_add_f32_dpp v83, v83, v83 row_ror:8 row_mask:0xf bank_mask:0x3
    v_add_f32_dpp v84, v84, v84 row_ror:8 row_mask:0xf bank_mask:0x3
    v_add_f32_dpp v85, v85, v85 row_ror:8 row_mask:0xf bank_mask:0x3
    v_add_f32_dpp v86, v86, v86 row_ror:8 row_mask:0xf bank_mask:0x3
    v_add_f32_dpp v87, v87, v87 row_ror:8 row_mask:0xf bank_mask:0x3
    v_add_f32_dpp v80, v88, v88 row_ror:8 row_mask:0xf bank_mask:0xc
    v_add_f32_dpp v81, v89, v89 row_ror:8 row_mask:0xf bank_mask:0xc
    v_add_f32_dpp v82, v90, v90 row_ror:8 row_mask:0xf bank_mask:0xc
    v_add_f32_dpp v83, v91, v91 row_ror:8 row_mask:0xf bank_mask:0xc
    v_add_f32_dpp v84, v92, v92 row_ror:8 row_mask:0xf bank_mask:0xc
    v_add_f32_dpp v85, v93, v93 row_ror:8 row_mask:0xf bank_mask:0xc
    v_add_f32_dpp v86, v94, v94 row_ror:8 row_mask:0xf bank_mask:0xc
    v_add_f32_dpp v87, v95, v95 row_ror:8 row_mask:0xf bank_mask:0xc
    v_add_f32_dpp v80, v80, v80 row_shl:4 row_mask:0xf bank_mask:0x5
    v_add_f32_dpp v81, v81, v81 row_shl:4 row_mask:0xf bank_mask:0x5
    v_add_f32_dpp v82, v82, v82 row_shl:4 row_mask:0xf bank_mask:0x5
    v_add_f32_dpp v83, v83, v83 row_shl:4 row_mask:0xf bank_mask:0x5
    v_add_f32_dpp v80, v84, v84 row_shr:4 row_mask:0xf bank_mask:0xa
    v_add_f32_dpp v81, v85, v85 row_shr:4 row_mask:0xf bank_mask:0xa
    v_add_f32_dpp v82, v86, v86 row_shr:4 row_mask:0xf bank_mask:0xa
    v_add_f32_dpp v83, v87, v87 row_shr:4 row_mask:0xf bank_mask:0xa
    ds_write_b128 v106, v[80:83]
    s_waitcnt lgkmcnt(0)
    s_barrier
    s_cmp_ge_u32 s3, 4
    s_cbranch_scc1 R5_78
    s_cmp_ge_u32 s3, 2
    s_cbranch_scc1 L_fin
    s_setprio 3
    ds_read_b64 v[32:33], v107 offset:0
    ds_read_b64 v[34:35], v107 offset:1024
    ds_read_b64 v[36:37], v107 offset:2048
    ds_read_b64 v[38:39], v107 offset:3072
    ds_read_b64 v[40:41], v107 offset:4096
    ds_read_b64 v[42:43], v107 offset:5120
    ds_read_b64 v[44:45], v107 offset:6144
    ds_read_b64 v[46:47], v107 offset:7168
    s_waitcnt lgkmcnt(6)
    v_add_f32 v32, v32, v34
    v_add_f32 v33, v33, v35
    s_waitcnt lgkmcnt(5)
    v_add_f32 v32, v32, v36
    v_add_f32 v33, v33, v37
    s_waitcnt lgkmcnt(4)
    v_add_f32 v32, v32, v38
    v_add_f32 v33, v33, v39
    s_waitcnt lgkmcnt(3)
    v_add_f32 v32, v32, v40
    v_add_f32 v33, v33, v41
    s_waitcnt lgkmcnt(2)
    v_add_f32 v32, v32, v42
    v_add_f32 v33, v33, v43
    s_waitcnt lgkmcnt(1)
    v_add_f32 v32, v32, v44
    v_add_f32 v33, v33, v45
    s_waitcnt lgkmcnt(0)
    v_add_f32 v32, v32, v46
    v_add_f32 v33, v33, v47
    v_cvt_pk_bf16_f32 v32, v32, v33
    v_mov_b32 v34, s11
    v_mov_b32 v35, s11
    v_mov_b32_dpp v33, v32 row_ror:8 row_mask:0xf bank_mask:0xf
    s_mov_b32 exec_lo, 0x00ff00ff
    s_mov_b32 exec_hi, 0x00ff00ff
    buffer_store_dwordx4 v[32:35], v108, s[40:43], s60 offen sc1
    s_mov_b64 exec, -1
    s_waitcnt vmcnt(0)
    s_mov_b64 exec, 1
    ds_add_u32 v4, v5 offset:24
    s_mov_b64 exec, -1
    s_branch L_fin
R5_78:
    v_lshlrev_b32 v44, 16, v120
    v_and_b32 v45, 0xffff0000, v120
    v_mov_b32 v50, s11
    v_mov_b32 v51, s11
    s_add_u32 s64, s60, 4096
    v_lshlrev_b32 v20, 2, v2
    s_and_b32 s14, s73, 3
    s_lshl2_add_u32 s13, s14, s12
    s_lshl4_add_u32 s70, s13, s67
    s_lshl_b32 s13, s13, 6
    s_add_u32 s65, s67, s13
    s_lshl_b32 s13, s12, 6
    s_lshl2_add_u32 s13, s14, s13
    s_add_u32 s66, s67, s13
    s_mov_b32 s15, 0
FW_80:
    ds_read_b32 v6, v4 offset:24
    s_add_u32 s15, s15, 1
    s_cmp_gt_u32 s15, 1600000
    s_cbranch_scc1 FX_81
    s_waitcnt lgkmcnt(0)
    v_readfirstlane_b32 s14, v6
    s_cmp_lt_u32 s14, 2
    s_cbranch_scc1 FW_80
FX_81:
    s_mov_b32 s61, 0
PL_82:
    buffer_load_dwordx4 v[64:67], v109, s[40:43], s60 offen sc1
    buffer_load_dwordx4 v[68:71], v109, s[40:43], s64 offen sc1
    s_waitcnt vmcnt(0)
    v_cmp_ne_u32 s[62:63], s11, v66
    v_cmp_ne_u32 vcc, s11, v70
    s_or_b64 s[62:63], s[62:63], vcc
    s_cmp_eq_u64 s[62:63], 0
    s_cbranch_scc1 PX_83
    s_add_u32 s61, s61, 1
    s_cmp_lt_u32 s61, 200000
    s_cbranch_scc1 PL_82
PX_83:
    v_lshlrev_b32 v72, 16, v64
    v_and_b32 v73, 0xffff0000, v64
    v_lshlrev_b32 v74, 16, v65
    v_and_b32 v75, 0xffff0000, v65
    v_lshlrev_b32 v76, 16, v68
    v_and_b32 v77, 0xffff0000, v68
    v_lshlrev_b32 v78, 16, v69
    v_and_b32 v79, 0xffff0000, v69
    v_add_f32 v72, v72, v76
    v_add_f32 v73, v73, v77
    v_add_f32 v74, v74, v78
    v_add_f32 v75, v75, v79
    v_add_f32_dpp v46, v72, v72 row_ror:8 row_mask:0xf bank_mask:0x3
    v_add_f32_dpp v47, v73, v73 row_ror:8 row_mask:0xf bank_mask:0x3
    v_add_f32_dpp v46, v74, v74 row_ror:8 row_mask:0xf bank_mask:0xc
    v_add_f32_dpp v47, v75, v75 row_ror:8 row_mask:0xf bank_mask:0xc
    v_mov_b32 v48, v46
    v_mov_b32 v49, v47
    s_nop 0
    v_permlane16_swap_b32 v46, v48
    v_permlane16_swap_b32 v47, v49
    s_nop 0
    v_add_f32 v46, v46, v48
    v_add_f32 v47, v47, v49
    v_mov_b32 v48, v46
    v_mov_b32 v49, v47
    s_nop 0
    v_permlane32_swap_b32 v46, v48
    v_permlane32_swap_b32 v47, v49
    s_nop 0
    v_add_f32 v46, v46, v48
    v_add_f32 v47, v47, v49
    v_cvt_pk_bf16_f32 v46, v46, v47
    s_mov_b64 exec, 0xffff
    v_lshlrev_b32 v48, 16, v46
    v_and_b32 v49, 0xffff0000, v46
    v_add_f32 v48, v48, v44
    v_add_f32 v49, v49, v45
    v_cvt_pk_bf16_f32 v46, v48, v49
    v_lshlrev_b32 v52, 16, v46
    v_and_b32 v53, 0xffff0000, v46
    v_add_u32_dpp v47, v46, v46 quad_perm:[1,0,3,2] row_mask:0xf bank_mask:0xf
    v_add_f32 v48, v52, v53
    s_nop 0
    v_add_u32_dpp v47, v47, v47 quad_perm:[2,3,0,1] row_mask:0xf bank_mask:0xf
    v_add_u32 v47, s11, v47
    s_cmp_lg_u32 s59, 1
    s_cbranch_scc1 LG_84
    buffer_store_dword v46, v20, s[40:43], s65 offen
    s_mov_b64 exec, 0x1111
    buffer_store_dword v47, v20, s[40:43], s66 offen offset:1024
    s_mov_b64 exec, 0xffff
    s_branch LE_85
LG_84:
    buffer_store_dword v46, v20, s[40:43], s65 offen sc1
    s_mov_b64 exec, 0x1111
    buffer_store_dword v47, v20, s[40:43], s66 offen offset:1024 sc1
    s_mov_b64 exec, 0xffff
LE_85:
    s_nop 1
    v_add_f32_dpp v48, v48, v48 row_ror:8 row_mask:0xf bank_mask:0xf
    s_nop 1
    v_add_f32_dpp v48, v48, v48 row_ror:4 row_mask:0xf bank_mask:0xf
    s_nop 1
    v_add_f32_dpp v48, v48, v48 row_ror:2 row_mask:0xf bank_mask:0xf
    s_nop 1
    v_add_f32_dpp v48, v48, v48 row_ror:1 row_mask:0xf bank_mask:0xf
    v_mul_f32 v54, 0x3d000000, v48
    v_sub_f32 v52, v52, v54
    v_sub_f32 v53, v53, v54
    v_mul_f32 v49, v52, v52
    v_fmac_f32 v49, v53, v53
    s_nop 1
    v_add_f32_dpp v49, v49, v49 row_ror:8 row_mask:0xf bank_mask:0xf
    s_nop 1
    v_add_f32_dpp v49, v49, v49 row_ror:4 row_mask:0xf bank_mask:0xf
    s_nop 1
    v_add_f32_dpp v49, v49, v49 row_ror:2 row_mask:0xf bank_mask:0xf
    s_nop 1
    v_add_f32_dpp v49, v49, v49 row_ror:1 row_mask:0xf bank_mask:0xf
    s_mov_b64 exec, 1
    s_cmp_lg_u32 s59, 1
    s_cbranch_scc1 LG_86
    buffer_store_dwordx4 v[48:51], v2, s[40:43], s70 offen offset:1280
    s_branch LE_87
LG_86:
    buffer_store_dwordx4 v[48:51], v2, s[40:43], s70 offen offset:1280 sc1
LE_87:
    s_add_u32 s13, s2, s12
    s_cmp_lg_u32 s13, 0
    s_cbranch_scc1 EP_88
    buffer_store_dword v50, v2, s[40:43], 0 offen sc1
EP_88:
    s_mov_b64 exec, -1
    s_branch L_fin
L_s6:
    s_barrier
    s_mov_b32 s48, s30
    s_and_b32 s49, s31, 0xffff
    s_mov_b32 s50, 2211840
    s_mov_b32 s51, 0x20000
    v_lshrrev_b32 v12, 2, v1
    v_mul_u32_u24 v12, 3456, v12
    v_and_b32 v7, 3, v1
    v_lshl_add_u32 v12, v7, 4, v12
    s_add_u32 s13, s3, 16
    s_mul_i32 s64, s13, 55296
    s_lshl_b32 s14, s73, 6
    s_add_u32 s64, s64, s14
    s_lshl_b32 s65, s3, 10
    s_add_u32 m0, s65, 49152
    s_add_u32 s13, s64, 0
    buffer_load_dwordx4 v12, s[48:51], s13 offen nt lds
    s_add_u32 m0, s65, 57344
    s_add_u32 s13, s64, 442368
    buffer_load_dwordx4 v12, s[48:51], s13 offen nt lds
    s_add_u32 m0, s65, 65536
    s_add_u32 s13, s64, 884736
    buffer_load_dwordx4 v12, s[48:51], s13 offen nt lds
    s_mov_b32 s44, s32
    s_and_b32 s45, s33, 0xffff
    s_mov_b32 s46, 2211840
    s_mov_b32 s47, 0x20000
    v_and_b32 v13, 7, v1
    v_xor_b32 v13, v13, v3
    s_and_b32 s13, s3, 1
    s_lshl_b32 s13, s13, 2
    v_xor_b32 v13, s13, v13
    v_lshrrev_b32 v7, 3, v1
    v_mul_u32_u24 v7, 1280, v7
    v_lshl_add_u32 v13, v13, 4, v7
    s_lshl2_add_u32 s64, s73, s12
    s_mul_i32 s64, s64, 10240
    s_lshr_b32 s13, s3, 2
    s_lshl_b32 s13, s13, 7
    s_add_u32 s64, s64, s13
    s_add_u32 m0, s65, 73728
    s_add_u32 s13, s64, 0
    buffer_load_dwordx4 v13, s[44:47], s13 offen nt lds
    s_add_u32 m0, s65, 81920
    s_add_u32 s13, s64, 256
    buffer_load_dwordx4 v13, s[44:47], s13 offen nt lds
    s_add_u32 m0, s65, 90112
    s_add_u32 s13, s64, 512
    buffer_load_dwordx4 v13, s[44:47], s13 offen nt lds
    s_add_u32 m0, s65, 98304
    s_add_u32 s13, s64, 768
    buffer_load_dwordx4 v13, s[44:47], s13 offen nt lds
    s_add_u32 m0, s65, 106496
    s_add_u32 s13, s64, 1024
    buffer_load_dwordx4 v13, s[44:47], s13 offen nt lds
    s_min_u32 s13, s3, 4
    s_lshl_b32 s64, s13, 7
    v_lshrrev_b32 v8, 2, v1
    v_and_b32 v8, 3, v8
    v_lshl_add_u32 v8, v3, 3, v8
    v_add_u32 v8, s64, v8
    v_lshlrev_b32 v8, 6, v8
    v_and_b32 v7, 3, v1
    v_lshl_add_u32 v8, v7, 4, v8
    v_add_u32 v8, 32768, v8
    v_lshlrev_b32 v10, 7, v2
    v_lshl_add_u32 v10, v3, 5, v10
    s_lshl_b32 s13, s3, 9
    s_add_u32 s13, s13, 114688
    v_add_u32 v10, s13, v10
    v_lshlrev_b32 v11, 3, v1
    v_add_u32 v11, 114688, v11
    s_mul_i32 s67, s4, 7680
    s_add_u32 s67, s67, 458752
    s_mul_i32 s65, s3, 1536
    s_add_u32 s65, s65, s67
    v_lshrrev_b32 v12, 2, v1
    v_and_b32 v12, 3, v12
    v_and_b32 v13, 3, v1
    v_lshrrev_b32 v20, 1, v13
    s_lshl_b32 s13, s12, 1
    v_or_b32 v20, s13, v20
    v_lshrrev_b32 v7, 1, v12
    v_xor_b32 v20, v20, v7
    v_and_b32 v7, 1, v3
    v_lshlrev_b32 v7, 2, v7
    v_xor_b32 v20, v20, v7
    v_lshlrev_b32 v20, 4, v20
    v_lshl_add_u32 v20, v12, 7, v20
    v_lshl_add_u32 v20, v3, 10, v20
    v_and_b32 v7, 1, v13
    v_lshl_add_u32 v20, v7, 3, v20
    s_lshr_b32 s13, s3, 2
    s_lshl_b32 s13, s13, 12
    s_add_u32 s13, s13, 73728
    v_add_u32 v20, s13, v20
    v_xor_b32 v21, 0x220, v20
    v_and_b32 v22, 3, v2
    v_lshlrev_b32 v22, 6, v22
    v_lshl_add_u32 v22, v3, 4, v22
    v_add_u32 v22, 122880, v22
    v_lshlrev_b32 v23, 4, v2
    v_lshl_add_u32 v29, v3, 11, v23
    v_lshrrev_b32 v7, 2, v2
    v_mov_b32 v28, 123136
    v_cmp_eq_u32 vcc, 0, v7
    v_cmp_eq_u32 s[74:75], 1, v7
    v_cmp_eq_u32 s[100:101], 2, v7
    v_cndmask_b32 v24, v28, v22, vcc
    v_cndmask_b32 v25, v28, v22, s[74:75]
    v_cmp_eq_u32 vcc, 3, v7
    v_cndmask_b32 v26, v28, v22, s[100:101]
    v_mov_b32 v30, 0
    v_mov_b32 v31, 0
    v_cndmask_b32 v27, v28, v22, vcc
    ds_write_b64 v28, v[30:31]
    ds_write_b64 v28, v[30:31] offset:8
    s_mul_i32 s68, s73, 10240
    s_lshl_b32 s13, s3, 8
    s_add_u32 s68, s68, s13
    s_add_u32 s68, s68, 983040
    s_add_u32 s69, s68, 4096
    s_add_u32 s70, s68, 8192
    v_mov_b32 v96, 0x3f803f80
    v_mov_b32 v97, 0x3f803f80
    v_mov_b32 v98, 0x3f803f80
    v_mov_b32 v99, 0x3f803f80
    v_mov_b32 v100, 0x3f803f80
    v_mov_b32 v101, 0x3f803f80
    v_mov_b32 v102, 0x3f803f80
    v_mov_b32 v103, 0x3f803f80
    v_mov_b32 v104, 0x3f803f80
    v_mov_b32 v105, 0x3f803f80
    v_mov_b32 v106, 0x3f803f80
    v_mov_b32 v107, 0x3f803f80
    v_mov_b32 v108, 0x3f803f80
    v_mov_b32 v109, 0x3f803f80
    v_mov_b32 v110, 0x3f803f80
    v_mov_b32 v111, 0x3f803f80
    v_mov_b32 v170, s11
    v_mov_b32 v171, s11
    v_mov_b32 v174, s11
    v_mov_b32 v175, s11
    s_waitcnt vmcnt(5)
    s_barrier
    s_cmp_eq_u32 s3, 7
    s_cbranch_scc1 F6_89
    s_cmp_ge_u32 s3, 5
    s_cbranch_scc1 I6_90
    ds_read_b64_tr_b16 v[64:65], v8 offset:0
    ds_read_b64_tr_b16 v[66:67], v8 offset:256
    ds_read_b64_tr_b16 v[68:69], v8 offset:8
    ds_read_b64_tr_b16 v[70:71], v8 offset:264
    ds_read_b64_tr_b16 v[72:73], v8 offset:2048
    ds_read_b64_tr_b16 v[74:75], v8 offset:2304
    ds_read_b64_tr_b16 v[76:77], v8 offset:2056
    ds_read_b64_tr_b16 v[78:79], v8 offset:2312
    ds_read_b64_tr_b16 v[80:81], v8 offset:4096
    ds_read_b64_tr_b16 v[82:83], v8 offset:4352
    ds_read_b64_tr_b16 v[84:85], v8 offset:4104
    ds_read_b64_tr_b16 v[86:87], v8 offset:4360
    ds_read_b64_tr_b16 v[88:89], v8 offset:6144
    ds_read_b64_tr_b16 v[90:91], v8 offset:6400
    ds_read_b64_tr_b16 v[92:93], v8 offset:6152
    ds_read_b64_tr_b16 v[94:95], v8 offset:6408
    s_waitcnt lgkmcnt(0)
    v_mfma_f32_16x16x32_bf16 v[56:59], v[64:67], v[96:99], 0
    v_mfma_f32_16x16x32_bf16 v[60:63], v[68:71], v[96:99], 0
    v_mfma_f32_16x16x32_bf16 v[56:59], v[72:75], v[100:103], v[56:59]
    v_mfma_f32_16x16x32_bf16 v[60:63], v[76:79], v[100:103], v[60:63]
    v_mfma_f32_16x16x32_bf16 v[56:59], v[80:83], v[104:107], v[56:59]
    v_mfma_f32_16x16x32_bf16 v[60:63], v[84:87], v[104:107], v[60:63]
    v_mfma_f32_16x16x32_bf16 v[56:59], v[88:91], v[108:111], v[56:59]
    v_mfma_f32_16x16x32_bf16 v[60:63], v[92:95], v[108:111], v[60:63]
    s_nop 5
    s_mov_b32 exec_lo, 0x000f000f
    s_mov_b32 exec_hi, 0x000f000f
    ds_write_b128 v10, v[56:59]
    ds_write_b128 v10, v[60:63] offset:16
    s_mov_b64 exec, -1
    s_waitcnt lgkmcnt(0)
    s_barrier
    s_waitcnt vmcnt(0)
    s_barrier
    ds_read_b64_tr_b16 v[128:129], v20 offset:0
    ds_read_b64_tr_b16 v[130:131], v21 offset:0
    ds_read_b64_tr_b16 v[132:133], v20 offset:8192
    ds_read_b64_tr_b16 v[134:135], v21 offset:8192
    ds_read_b64_tr_b16 v[136:137], v20 offset:16384
    ds_read_b64_tr_b16 v[138:139], v21 offset:16384
    ds_read_b64_tr_b16 v[140:141], v20 offset:24576
    ds_read_b64_tr_b16 v[142:143], v21 offset:24576
    ds_read_b64_tr_b16 v[144:145], v20 offset:32768
    ds_read_b64_tr_b16 v[146:147], v21 offset:32768
    s_mov_b32 s61, 0
PL_92:
    s_mov_b32 exec_lo, 0x000f000f
    s_mov_b32 exec_hi, 0x000f000f
    buffer_load_dwordx4 v[96:99], v15, s[40:43], s65 offen offset:0 sc1
    buffer_load_dwordx4 v[100:103], v15, s[40:43], s65 offen offset:256 sc1
    buffer_load_dwordx4 v[104:107], v15, s[40:43], s65 offen offset:512 sc1
    buffer_load_dwordx4 v[108:111], v15, s[40:43], s65 offen offset:768 sc1
    buffer_load_dwordx4 v[112:115], v15, s[40:43], s65 offen offset:1024 sc1
    s_mov_b64 exec, -1
    s_waitcnt vmcnt(1)
    v_mfma_f32_16x16x32_bf16 v[56:59], v[64:67], v[96:99], 0
    v_mfma_f32_16x16x32_bf16 v[60:63], v[68:71], v[96:99], 0
    v_mfma_f32_16x16x32_bf16 v[56:59], v[72:75], v[100:103], v[56:59]
    v_mfma_f32_16x16x32_bf16 v[60:63], v[76:79], v[100:103], v[60:63]
    v_mfma_f32_16x16x32_bf16 v[56:59], v[80:83], v[104:107], v[56:59]
    v_mfma_f32_16x16x32_bf16 v[60:63], v[84:87], v[104:107], v[60:63]
    v_mfma_f32_16x16x32_bf16 v[56:59], v[88:91], v[108:111], v[56:59]
    v_mfma_f32_16x16x32_bf16 v[60:63], v[92:95], v[108:111], v[60:63]
    s_mov_b32 exec_lo, 0x000f000f
    s_mov_b32 exec_hi, 0x000f000f
    s_waitcnt vmcnt(0)
    v_add3_u32 v7, v96, v97, s11
    v_add3_u32 v7, v98, v99, v7
    v_cmp_ne_u32 s[62:63], v7, v112
    v_add3_u32 v7, v100, v101, s11
    v_add3_u32 v7, v102, v103, v7
    v_cmp_ne_u32 vcc, v7, v113
    s_or_b64 s[62:63], s[62:63], vcc
    v_add3_u32 v7, v104, v105, s11
    v_add3_u32 v7, v106, v107, v7
    v_cmp_ne_u32 vcc, v7, v114
    s_or_b64 s[62:63], s[62:63], vcc
    v_add3_u32 v7, v108, v109, s11
    v_add3_u32 v7, v110, v111, v7
    v_cmp_ne_u32 vcc, v7, v115
    s_or_b64 s[62:63], s[62:63], vcc
    s_cmp_eq_u64 s[62:63], 0
    s_cbranch_scc1 PX_93
    s_add_u32 s61, s61, 1
    s_cmp_lt_u32 s61, 200000
    s_cbranch_scc1 PL_92
PX_93:
    ds_write_b128 v10, v[56:59]
    ds_write_b128 v10, v[60:63] offset:16
    s_mov_b64 exec, -1
    s_waitcnt lgkmcnt(0)
    s_barrier
    s_branch W6_91
I6_90:
    s_barrier
    s_waitcnt vmcnt(0)
    s_barrier
    ds_read_b64_tr_b16 v[128:129], v20 offset:0
    ds_read_b64_tr_b16 v[130:131], v21 offset:0
    ds_read_b64_tr_b16 v[132:133], v20 offset:8192
    ds_read_b64_tr_b16 v[134:135], v21 offset:8192
    ds_read_b64_tr_b16 v[136:137], v20 offset:16384
    ds_read_b64_tr_b16 v[138:139], v21 offset:16384
    ds_read_b64_tr_b16 v[140:141], v20 offset:24576
    ds_read_b64_tr_b16 v[142:143], v21 offset:24576
    ds_read_b64_tr_b16 v[144:145], v20 offset:32768
    ds_read_b64_tr_b16 v[146:147], v21 offset:32768
    s_barrier
    s_branch W6_91
F6_89:
    s_barrier
    ds_read_b64 v[32:33], v11 offset:0
    ds_read_b64 v[34:35], v11 offset:512
    ds_read_b64 v[36:37], v11 offset:1024
    ds_read_b64 v[38:39], v11 offset:1536
    ds_read_b64 v[40:41], v11 offset:2048
    s_waitcnt lgkmcnt(3)
    v_add_f32 v32, v32, v34
    v_add_f32 v33, v33, v35
    s_waitcnt lgkmcnt(2)
    v_add_f32 v32, v32, v36
    v_add_f32 v33, v33, v37
    s_waitcnt lgkmcnt(1)
    v_add_f32 v32, v32, v38
    v_add_f32 v33, v33, v39
    s_waitcnt lgkmcnt(0)
    v_add_f32 v32, v32, v40
    v_add_f32 v33, v33, v41
    v_mov_b32 v60, v32
    v_mov_b32 v61, v33
    s_waitcnt vmcnt(0)
    s_barrier
    ds_read_b64_tr_b16 v[128:129], v20 offset:0
    ds_read_b64_tr_b16 v[130:131], v21 offset:0
    ds_read_b64_tr_b16 v[132:133], v20 offset:8192
    ds_read_b64_tr_b16 v[134:135], v21 offset:8192
    ds_read_b64_tr_b16 v[136:137], v20 offset:16384
    ds_read_b64_tr_b16 v[138:139], v21 offset:16384
    ds_read_b64_tr_b16 v[140:141], v20 offset:24576
    ds_read_b64_tr_b16 v[142:143], v21 offset:24576
    ds_read_b64_tr_b16 v[144:145], v20 offset:32768
    ds_read_b64_tr_b16 v[146:147], v21 offset:32768
    s_nop 0
    v_lshrrev_b32 v16, 2, v2
    v_mul_u32_u24 v16, 1536, v16
    v_and_b32 v17, 3, v2
    v_lshl_add_u32 v16, v17, 6, v16
    v_lshl_add_u32 v16, v3, 4, v16
    v_mov_b32 v48, 0
    v_mov_b32 v49, 0
    v_mov_b32 v50, s11
    v_cmp_gt_u32 vcc, 4, v2
    v_mov_b32 v42, 0
    v_lshlrev_b32 v17, 2, v1
    v_cndmask_b32 v42, v42, 1.0, vcc
    v_add_u32 v17, 122880, v17
    s_add_u32 s66, s67, 6144
    s_mov_b32 s61, 0
PL_94:
    buffer_load_dwordx4 v[44:47], v16, s[40:43], s67 offen offset:1280 sc1
    s_mov_b32 exec_lo, 0x000f000f
    s_mov_b32 exec_hi, 0x000f000f
    buffer_load_dwordx4 v[48:51], v16, s[40:43], s66 offen offset:1280 sc1
    s_mov_b64 exec, -1
    s_waitcnt vmcnt(0)
    v_cmp_ne_u32 s[62:63], s11, v46
    v_cmp_ne_u32 vcc, s11, v50
    s_or_b64 s[62:63], s[62:63], vcc
    s_cmp_eq_u64 s[62:63], 0
    s_cbranch_scc1 PX_95
    s_add_u32 s61, s61, 1
    s_cmp_lt_u32 s61, 200000
    s_cbranch_scc1 PL_94
PX_95:
    v_add_f32 v52, v44, v48
    s_nop 1
    v_add_f32_dpp v52, v52, v52 row_ror:8 row_mask:0xf bank_mask:0xf
    s_nop 1
    v_add_f32_dpp v52, v52, v52 row_ror:4 row_mask:0xf bank_mask:0xf
    s_nop 1
    v_add_f32_dpp v52, v52, v52 row_ror:2 row_mask:0xf bank_mask:0xf
    s_nop 1
    v_add_f32_dpp v52, v52, v52 row_ror:1 row_mask:0xf bank_mask:0xf
    v_mul_f32 v52, 0x3acccccd, v52
    v_mul_f32 v44, 0x3d000000, v44
    v_mul_f32 v48, 0x3d000000, v48
    v_sub_f32 v44, v44, v52
    v_sub_f32 v48, v48, v52
    v_mul_f32 v48, v48, v42
    v_mul_f32 v44, v44, v44
    v_fmac_f32 v44, v48, v48
    v_add_f32 v53, v45, v49
    v_fmac_f32 v53, 0x42000000, v44
    s_nop 1
    v_add_f32_dpp v53, v53, v53 row_ror:8 row_mask:0xf bank_mask:0xf
    s_nop 1
    v_add_f32_dpp v53, v53, v53 row_ror:4 row_mask:0xf bank_mask:0xf
    s_nop 1
    v_add_f32_dpp v53, v53, v53 row_ror:2 row_mask:0xf bank_mask:0xf
    s_nop 1
    v_add_f32_dpp v53, v53, v53 row_ror:1 row_mask:0xf bank_mask:0xf
    v_mov_b32 v54, 0x3727c5ac
    v_fmac_f32 v54, 0x3acccccd, v53
    v_rsq_f32 v54, v54
    v_mul_f32 v60, v60, v52
    v_mul_f32 v61, v61, v52
    v_mul_f32 v55, 0xbfb8aa3b, v54
    s_barrier
    ds_read_b64 v[32:33], v11 offset:0
    ds_read_b64 v[34:35], v11 offset:512
    ds_read_b64 v[36:37], v11 offset:1024
    ds_read_b64 v[38:39], v11 offset:1536
    ds_read_b64 v[40:41], v11 offset:2048
    s_waitcnt lgkmcnt(3)
    v_add_f32 v32, v32, v34
    v_add_f32 v33, v33, v35
    s_waitcnt lgkmcnt(2)
    v_add_f32 v32, v32, v36
    v_add_f32 v33, v33, v37
    s_waitcnt lgkmcnt(1)
    v_add_f32 v32, v32, v38
    v_add_f32 v33, v33, v39
    s_waitcnt lgkmcnt(0)
    v_add_f32 v32, v32, v40
    v_add_f32 v33, v33, v41
    v_sub_f32 v32, v32, v60
    v_sub_f32 v33, v33, v61
    v_mul_f32 v34, v32, v55
    v_mul_f32 v35, v33, v55
    v_exp_f32 v34, v34
    v_exp_f32 v35, v35
    v_mul_f32 v32, v32, v54
    v_mul_f32 v33, v33, v54
    v_add_f32 v34, 1.0, v34
    v_add_f32 v35, 1.0, v35
    v_rcp_f32 v34, v34
    v_rcp_f32 v35, v35
    s_nop 0
    v_mul_f32 v32, v32, v34
    v_mul_f32 v33, v33, v35
    v_cvt_pk_bf16_f32 v32, v32, v33
    ds_write_b32 v17, v32
W6_91:
    s_waitcnt lgkmcnt(0)
    s_barrier
    ds_read_b128 v[180:183], v24
    ds_read_b128 v[184:187], v25
    ds_read_b128 v[188:191], v26
    ds_read_b128 v[192:195], v27
    s_waitcnt lgkmcnt(3)
    v_mfma_f32_16x16x32_bf16 v[152:155], v[180:183], v[144:147], 0
    v_mfma_f32_16x16x32_bf16 v[148:151], v[180:183], v[128:131], 0
    s_waitcnt lgkmcnt(2)
    v_mfma_f32_16x16x32_bf16 v[148:151], v[184:187], v[132:135], v[148:151]
    s_waitcnt lgkmcnt(1)
    v_mfma_f32_16x16x32_bf16 v[148:151], v[188:191], v[136:139], v[148:151]
    s_waitcnt lgkmcnt(0)
    v_mfma_f32_16x16x32_bf16 v[148:151], v[192:195], v[140:143], v[148:151]
    s_nop 1
    s_mov_b64 exec, 0xffff
    v_cvt_pk_bf16_f32 v172, v152, v153
    v_cvt_pk_bf16_f32 v173, v154, v155
    buffer_store_dwordx4 v[172:175], v23, s[40:43], s70 offen sc1
    s_mov_b64 exec, -1
    s_nop 0
    v_cvt_pk_bf16_f32 v168, v148, v149
    v_cvt_pk_bf16_f32 v169, v150, v151
    buffer_store_dwordx4 v[168:171], v29, s[40:43], s68 offen sc1
    s_branch L_fin
L_s7:
    v_lshlrev_b32 v10, 2, v1
    v_add_u32 v16, 114688, v10
    s_cmp_eq_u32 s3, 7
    s_cbranch_scc1 H7_96
    v_mul_u32_u24 v12, 10240, v3
    v_lshl_add_u32 v12, v2, 4, v12
    s_mul_i32 s65, s3, 81920
    s_lshl_b32 s13, s73, 8
    s_add_u32 s65, s65, s13
    s_add_u32 s65, s65, 983040
    s_add_u32 s66, s65, 40960
    s_mov_b64 s[74:75], -1
    s_cmp_eq_u32 s3, 6
    s_cselect_b32 s75, 0, s75
    v_mov_b32 v100, 0
    v_mov_b32 v101, 0
    v_mov_b32 v102, s11
    s_lshl_b32 s13, s3, 8
    v_add_u32 v10, s13, v16
    s_barrier
    s_mov_b32 s61, 0
PL_98:
    buffer_load_dwordx4 v[96:99], v12, s[40:43], s65 offen sc1
    s_mov_b64 exec, s[74:75]
    buffer_load_dwordx4 v[100:103], v12, s[40:43], s66 offen sc1
    s_mov_b64 exec, -1
    s_waitcnt vmcnt(0)
    v_cmp_ne_u32 s[62:63], s11, v98
    v_cmp_ne_u32 vcc, s11, v102
    s_or_b64 s[62:63], s[62:63], vcc
    s_cmp_eq_u64 s[62:63], 0
    s_cbranch_scc1 PX_99
    s_add_u32 s61, s61, 1
    s_cmp_lt_u32 s61, 200000
    s_cbranch_scc1 PL_98
PX_99:
    v_lshlrev_b32 v24, 16, v96
    v_and_b32 v25, 0xffff0000, v96
    v_lshlrev_b32 v26, 16, v97
    v_and_b32 v27, 0xffff0000, v97
    v_lshlrev_b32 v28, 16, v100
    v_and_b32 v29, 0xffff0000, v100
    v_lshlrev_b32 v30, 16, v101
    v_and_b32 v31, 0xffff0000, v101
    v_add_f32 v24, v24, v28
    v_add_f32 v25, v25, v29
    v_add_f32 v26, v26, v30
    v_add_f32 v27, v27, v31
    s_nop 0
    v_permlane16_swap_b32 v24, v25
    v_permlane16_swap_b32 v26, v27
    s_nop 0
    v_add_f32 v24, v24, v25
    v_add_f32 v26, v26, v27
    s_nop 1
    v_permlane32_swap_b32 v24, v26
    s_nop 0
    v_add_f32 v24, v24, v26
    ds_write_b32 v10, v24
    s_waitcnt lgkmcnt(0)
    s_barrier
    s_branch L_fin
H7_96:
    s_mov_b32 s48, s34
    s_and_b32 s49, s35, 0xffff
    s_mov_b32 s50, 5120
    s_mov_b32 s51, 0x20000
    v_mul_u32_u24 v13, 1280, v3
    v_lshl_add_u32 v13, v2, 1, v13
    v_lshrrev_b32 v8, 3, v2
    v_lshl_add_u32 v12, v3, 2, v8
    v_lshlrev_b32 v11, 4, v12
    s_lshl_b32 s64, s73, 5
    s_mul_i32 s65, s4, 5
    s_lshr_b32 s13, s73, 3
    s_add_u32 s65, s65, s13
    s_mul_i32 s65, s65, 1536
    s_add_u32 s65, s65, 458752
    s_and_b32 s13, s73, 1
    s_lshl_b32 s13, s13, 5
    s_add_u32 s65, s65, s13
    s_lshr_b32 s13, s73, 1
    s_and_b32 s13, s13, 3
    s_lshl2_add_u32 s66, s13, s65
    s_lshl_b32 s13, s13, 8
    s_add_u32 s65, s65, s13
    s_mov_b32 s61, 0
PL_100:
    buffer_load_dwordx4 v[24:27], v11, s[40:43], s65 offen sc1
    buffer_load_dword v28, v11, s[40:43], s66 offen offset:1024 sc1
    s_waitcnt vmcnt(0)
    v_add3_u32 v7, v24, v25, s11
    v_add3_u32 v7, v26, v27, v7
    v_cmp_ne_u32 s[62:63], v7, v28
    s_cmp_eq_u64 s[62:63], 0
    s_cbranch_scc1 PX_101
    s_add_u32 s61, s61, 1
    s_cmp_lt_u32 s61, 200000
    s_cbranch_scc1 PL_100
PX_101:
    s_barrier
    v_and_b32 v8, 2, v1
    v_cmp_ne_u32 vcc, 0, v8
    v_and_b32 v9, 4, v1
    v_cmp_ne_u32 s[74:75], 0, v9
    v_cndmask_b32 v24, v24, v25, vcc
    v_cndmask_b32 v26, v26, v27, vcc
    v_and_b32 v8, 1, v1
    v_cmp_ne_u32 vcc, 0, v8
    v_cndmask_b32 v24, v24, v26, s[74:75]
    v_lshlrev_b32 v25, 16, v24
    v_and_b32 v26, 0xffff0000, v24
    v_cndmask_b32 v30, v25, v26, vcc
    s_barrier
    ds_read_b32 v64, v16 offset:0
    ds_read_b32 v65, v16 offset:256
    ds_read_b32 v66, v16 offset:512
    ds_read_b32 v67, v16 offset:768
    ds_read_b32 v68, v16 offset:1024
    ds_read_b32 v69, v16 offset:1280
    ds_read_b32 v70, v16 offset:1536
    s_waitcnt lgkmcnt(4)
    v_add_f32 v64, v64, v65
    v_add_f32 v64, v64, v66
    s_waitcnt lgkmcnt(2)
    v_add_f32 v67, v67, v68
    s_waitcnt lgkmcnt(0)
    v_add_f32 v69, v69, v70
    v_add_f32 v64, v64, v67
    v_add_f32 v64, v64, v69
    v_cvt_pk_bf16_f32 v64, v64, v64
    v_lshlrev_b32 v64, 16, v64
    v_add_f32 v64, v64, v30
    v_cvt_pk_bf16_f32 v64, v64, v64
    buffer_store_short v64, v13, s[48:51], s64 offen
L_fin:
    s_endpgm
L_end:
    s_endpgm
L_code_end:
.section .rodata,"a"
.p2align 6
.amdhsa_kernel sequential_preLN__compressed_kv_cla__dense_activation_silu__decode_kernel
  .amdhsa_next_free_vgpr 256
  .amdhsa_next_free_sgpr 102
  .amdhsa_accum_offset 256
  .amdhsa_group_segment_fixed_size 0
  .amdhsa_kernarg_size 96
  .amdhsa_user_sgpr_count 2
  .amdhsa_user_sgpr_kernarg_segment_ptr 1
  .amdhsa_system_sgpr_workgroup_id_x 1
.end_amdhsa_kernel
```
